```python
import torch

def _softmax(x, axis=-1):
    return torch.softmax(x, dim=axis)
def _gelu(x):
    return torch.nn.functional.gelu(x, approximate="tanh")
def _silu(x):
    return torch.nn.functional.silu(x)
def _sigmoid(x):
    return torch.sigmoid(x)
def _layernorm(x, axis=-1, eps=1e-5):
    m = x.mean(dim=axis, keepdim=True)
    v = x.var(dim=axis, keepdim=True, unbiased=False)
    return (x - m) / torch.sqrt(v + eps)
def _scatter_add(tgt, idx, src, axis=0):
    return tgt.clone().index_add_(axis, idx, src)
def _segment_sum(src, seg, n):
    out = torch.zeros((n,) + src.shape[1:], dtype=src.dtype)
    return out.index_add_(0, seg, src)
def _pad(x, pw):
    flat = tuple(v for pair in reversed(pw) for v in pair)
    return torch.nn.functional.pad(x, flat)

kernel_name = 'standalone__w4a16_gemm_dequant__prompt'

def setup_inputs():

    _w = (lambda a: (lambda t: t.to(torch.bfloat16) if t.is_floating_point() else t)(torch.as_tensor(a)))
    B, S, D, F = 1, 2048, 576, 4608
    G = -1 if -1 > 0 else D
    D = (D // G) * G
    ng = D // G
    qw = torch.randint(0, 16, (D, F)).to(torch.int32)
    return {
        "x": _w((lambda *s: torch.randn(*s, dtype=torch.bfloat16) * 0.05)(B, S, D)),
        "qw": _w(qw),
        "scales": _w(torch.abs((lambda *s: torch.randn(*s, dtype=torch.bfloat16) * 0.05)(ng, F)) + 0.01),
        "zeros": _w(torch.full((ng, F), 8.0, dtype=float)),
    }

def reference(x, qw, scales, zeros):
    B, S, D = x.shape
    ng, F = scales.shape
    G = D // ng
    s = (lambda x, n, axis: torch.repeat_interleave(x, n, dim=axis))(scales, G, axis=0)
    z = (lambda x, n, axis: torch.repeat_interleave(x, n, dim=axis))(zeros, G, axis=0)
    w = ((lambda x, dt: x.to(dt))(qw, x.dtype) - z) * s
    return x @ w
```

```asm
; @launch grid=(256,1,1) block=(256,1,1) lds=163840
.amdgcn_target "amdgcn-amd-amdhsa--gfx950"
.text
.globl standalone__w4a16_gemm_dequant__prompt_kernel
.p2align 12
.type standalone__w4a16_gemm_dequant__prompt_kernel,@function
standalone__w4a16_gemm_dequant__prompt_kernel:
    s_cmp_ge_u32 s2, 256
    s_cbranch_scc1 L_done
    s_load_dwordx2 s[12:13], s[0:1], 8
    s_load_dwordx2 s[16:17], s[0:1], 16
    s_load_dwordx2 s[20:21], s[0:1], 24
    s_load_dwordx2 s[8:9], s[0:1], 0
    s_load_dwordx2 s[24:25], s[0:1], 32
    v_lshrrev_b32 v1, 6, v0
    v_and_b32 v2, 63, v0
    s_lshr_b32 s29, s2, 3
    v_readfirstlane_b32 s40, v1
    s_and_b32 s39, s29, 3
    s_and_b32 s28, s2, 7
    s_and_b32 s30, s28, 1
    s_lshl_b32 s30, s30, 5
    s_add_u32 s29, s29, s30
    s_cmp_eq_u32 s29, 63
    s_cbranch_scc1 L_fin
    s_mul_i32 s31, s29, 37
    s_lshr_b32 s31, s31, 8
    s_mul_i32 s30, s31, 7
    s_sub_u32 s30, s29, s30
    s_lshr_b32 s28, s28, 1
    s_mul_i32 s28, s28, 9
    s_add_u32 s31, s31, s28
    s_add_u32 s36, s30, s31
    s_mul_i32 s37, s36, 37
    s_lshr_b32 s37, s37, 8
    s_mul_i32 s37, s37, 7
    s_sub_u32 s4, s36, s37
    s_lshl_b32 s76, s4, 7
    s_cmp_lt_u32 s4, 3
    s_cselect_b32 s76, s76, 0
    s_mul_i32 s32, s30, 331776
    s_getpc_b64 s[44:45]
L_pc:
    v_and_b32 v3, 15, v0
    v_lshl_add_u32 v3, v1, 4, v3
    s_lshl_b32 s39, s39, 6
    v_add_u32 v3, s39, v3
    s_mov_b32 s39, L_pathF-L_pc
    s_cmp_lt_u32 s4, 3
    s_cselect_b32 s39, L_pathL-L_pc, s39
    v_lshl_add_u32 v3, v3, 7, s39
    v_min_u32 v3, L_fastend-L_pc, v3
    s_mov_b64 exec, 0xffff
    global_load_dword v255, v3, s[44:45]
    s_mov_b64 exec, -1
    s_and_b32 s41, s40, 1
    s_lshr_b32 s42, s40, 1
    s_mov_b32 s14, 10616832
    s_mov_b32 s15, 0x20000
    s_mov_b32 s18, 9216
    s_mov_b32 s19, 0x20000
    s_mov_b32 s22, 9216
    s_mov_b32 s23, 0x20000
    v_and_b32 v4, 15, v2
    v_bfe_u32 v5, v2, 4, 1
    v_lshrrev_b32 v6, 5, v2
    v_lshlrev_b32 v7, 1, v5
    v_add_u32 v7, v7, v6
    v_mul_u32_u24 v7, 147456, v7
    v_lshl_add_u32 v9, v4, 4, v7
    s_lshl_b32 s33, s31, 1
    s_add_u32 s33, s33, s41
    s_lshl_b32 s34, s33, 7
    s_lshl_b32 s35, s33, 8
    s_mul_i32 s36, s42, 589824
    s_add_u32 s60, s35, s36
    v_lshlrev_b32 v22, 3, v4
    s_mul_i32 s35, s76, 9216
    v_add_u32_e32 v8, s35, v9
    s_add_u32 s61, s60, 18432
    s_add_u32 s62, s60, 36864
    s_waitcnt lgkmcnt(0)
    buffer_load_dwordx2 v[26:27], v22, s[16:19], s34 offen
    buffer_load_dwordx2 v[28:29], v22, s[20:23], s34 offen
    buffer_load_dwordx4 v[176:179], v8, s[12:15], s60 offen
    s_add_u32 s63, s60, 55296
    s_add_u32 s64, s60, 73728
    s_add_u32 s65, s60, 92160
    s_add_u32 s66, s60, 110592
    s_add_u32 s67, s60, 129024
    v_lshrrev_b32 v7, 3, v0
    v_mul_u32_u24 v10, 1152, v7
    v_lshrrev_b32 v7, 1, v7
    v_xor_b32 v7, v7, v0
    v_and_b32 v7, 7, v7
    buffer_load_dwordx4 v[180:183], v8, s[12:15], s61 offen
    v_lshl_add_u32 v10, v7, 4, v10
    s_lshl_b32 s43, s40, 11
    s_mov_b32 s10, 2359296
    s_mov_b32 s11, 0x20000
    s_mov_b32 s50, s32
    s_add_u32 s55, s32, 35840
    s_add_u32 s51, s32, 73728
    s_add_u32 s56, s32, 109568
    s_add_u32 s52, s32, 147456
    s_add_u32 s57, s32, 183296
    buffer_load_dwordx4 v[184:187], v8, s[12:15], s62 offen
    s_mov_b32 s26, 18874368
    s_mov_b32 s27, 0x20000
    v_lshrrev_b32_e32 v3, 4, v2
    v_lshrrev_b32_e32 v7, 1, v4
    v_xor_b32_e32 v7, v7, v3
    v_lshrrev_b32_e32 v0, 3, v4
    v_lshl_add_u32 v22, v3, 2, v0
    v_and_b32_e32 v3, 7, v4
    v_mul_u32_u24 v22, 9216, v22
    v_lshl_add_u32 v22, v3, 4, v22
    buffer_load_dwordx4 v[188:191], v8, s[12:15], s63 offen
    v_add_u32_e32 v22, s34, v22
    v_lshlrev_b32_e32 v3, 7, v3
    v_lshl_add_u32 v3, v0, 11, v3
    s_lshl_b32 s36, s42, 10
    v_lshl_add_u32 v7, v7, 4, s36
    v_add_u32_e32 v12, v7, v3
    v_xor_b32_e32 v13, 64, v12
    v_add_u32_e32 v14, 0x10000, v12
    v_add_u32_e32 v15, 0x10000, v13
    s_lshl_b32 s36, s41, 13
    buffer_load_dwordx4 v[192:195], v8, s[12:15], s64 offen
    s_add_u32 s36, s36, 131072
    v_lshrrev_b32_e32 v3, 1, v2
    v_and_b32_e32 v3, 4, v3
    v_xor_b32_e32 v3, v3, v2
    v_lshl_add_u32 v21, v3, 4, s36
    s_lshl_b32 s37, s42, 12
    s_add_u32 s36, s36, s37
    v_and_b32_e32 v3, 1, v4
    v_mul_u32_u24_e32 v3, 12, v3
    v_lshrrev_b32_e32 v7, 1, v4
    buffer_load_dwordx4 v[196:199], v8, s[12:15], s65 offen
    v_xor_b32_e32 v3, v3, v7
    v_lshl_add_u32 v20, v3, 4, s36
    v_lshl_add_u32 v20, v5, 9, v20
    v_lshl_add_u32 v20, v6, 8, v20
    s_mov_b32 s73, 18432
    s_mov_b32 s74, 147456
    s_mov_b32 s75, 165888
    v_mov_b32_e32 v24, 0
    v_mov_b32_e32 v25, 0
    s_mov_b32 s37, 0x4b800000
    buffer_load_dwordx4 v[200:203], v8, s[12:15], s66 offen
    s_mov_b32 s38, 0xffff0000
    s_mov_b64 s[46:47], 0
    s_mov_b32 s68, 0x41000000
    s_mov_b32 s69, 0x41800000
    s_mov_b32 s70, 0x0dffffff
    s_mov_b32 s71, 0x7fffffff
    s_mov_b32 s72, 0x71800000
    buffer_load_dwordx4 v[204:207], v8, s[12:15], s67 offen
    s_add_u32 m0, s43, 0
    v_add_u32_e32 v11, s76, v10
    buffer_load_dwordx4 v11, s[8:11], s50 offen lds
    buffer_load_dwordx4 v11, s[8:11], s55 offen offset:1024 lds
    s_add_u32 m0, s43, 8192
    s_nop 0
    buffer_load_dwordx4 v11, s[8:11], s51 offen lds
    s_cmp_lt_u32 s4, 3
    s_cbranch_scc0 L_pathF
    .p2align 3
L_pathL:
    s_mul_i32 s36, s31, 1
    s_mul_i32 s33, s36, 512
    s_lshr_b32 s33, s33, 10
    s_mul_i32 s33, s33, 2
    s_sub_u32 s36, s36, s33
    s_mul_i32 s36, s36, 36864
    s_add_u32 s45, s32, 221184
    s_add_u32 s44, s32, 294912
    s_add_u32 s36, s36, s45
    s_mov_b32 s53, s36
    s_add_u32 s36, s36, 36864
    s_cmp_eq_u32 s36, s44
    s_cselect_b32 s36, s45, s36
    s_sub_u32 s58, s36, 1024
    s_add_u32 s33, s55, 1024
    s_cmp_eq_u32 s42, 0
    s_cselect_b32 s85, s50, s33
    s_add_u32 s33, s56, 1024
    s_cmp_eq_u32 s42, 0
    s_cselect_b32 s86, s51, s33
    s_add_u32 s33, s57, 1024
    s_cmp_eq_u32 s42, 0
    s_cselect_b32 s87, s52, s33
    s_add_u32 s33, s58, 1024
    s_cmp_eq_u32 s42, 0
    s_cselect_b32 s88, s53, s33
    s_mov_b32 s7, 4
    s_add_u32 s77, s76, 384
    s_sub_u32 s101, s77, 1152
    s_cselect_b32 s77, s77, s101
    s_add_u32 s78, s77, 384
    s_sub_u32 s101, s78, 1152
    s_cselect_b32 s78, s78, s101
    s_add_u32 s79, s78, 512
    s_sub_u32 s101, s79, 1152
    s_cselect_b32 s79, s79, s101
    s_add_u32 s80, s79, 384
    s_sub_u32 s101, s80, 1152
    s_cselect_b32 s80, s80, s101
    s_add_u32 s81, s80, 384
    s_sub_u32 s101, s81, 1152
    s_cselect_b32 s81, s81, s101
    s_add_u32 s82, s81, 512
    s_sub_u32 s101, s82, 1152
    s_cselect_b32 s82, s82, s101
    s_add_u32 s83, s82, 384
    s_sub_u32 s101, s83, 1152
    s_cselect_b32 s83, s83, s101
    s_add_u32 s84, s83, 384
    s_sub_u32 s101, s84, 1152
    s_cselect_b32 s84, s84, s101
    s_mov_b64 exec, 0
    s_cmp_eq_u32 s40, 0
    s_cbranch_scc1 L_tL0
    s_cmp_eq_u32 s40, 1
    s_cbranch_scc1 L_tL1
    s_cmp_eq_u32 s40, 2
    s_cbranch_scc1 L_tL2
L_retL:
    s_mov_b64 exec, -1
    s_waitcnt vmcnt(11)
    v_lshlrev_b32_e32 v40, 16, v26
    v_lshlrev_b32_e32 v44, 16, v28
    v_mul_f32_e64 v34, -v44, v40
    v_mul_f32_e32 v30, s37, v40
    v_and_b32_e32 v41, s38, v26
    v_and_b32_e32 v45, s38, v28
    v_mul_f32_e64 v35, -v45, v41
    v_mul_f32_e32 v31, s37, v41
    v_lshlrev_b32_e32 v42, 16, v27
    v_lshlrev_b32_e32 v46, 16, v29
    v_mul_f32_e64 v36, -v46, v42
    v_mul_f32_e32 v32, s37, v42
    v_and_b32_e32 v43, s38, v27
    v_and_b32_e32 v47, s38, v29
    v_mul_f32_e64 v37, -v47, v43
    v_mul_f32_e32 v33, s37, v43
    s_waitcnt vmcnt(9)
    buffer_load_dwordx4 v11, s[8:11], s56 offen offset:1024 lds
    s_add_u32 m0, s43, 16384
    s_nop 0
    buffer_load_dwordx4 v11, s[8:11], s52 offen lds
    v_or3_b32 v24, v24, v176, v180
    v_fma_mix_f32 v176, v176, v30, v34 op_sel_hi:[1,0,0]
    v_fma_mix_f32 v180, v180, v30, v34 op_sel_hi:[1,0,0]
    v_or3_b32 v25, v25, v177, v181
    v_fma_mix_f32 v177, v177, v31, v35 op_sel_hi:[1,0,0]
    v_fma_mix_f32 v181, v181, v31, v35 op_sel_hi:[1,0,0]
    v_or3_b32 v24, v24, v178, v182
    v_fma_mix_f32 v178, v178, v32, v36 op_sel_hi:[1,0,0]
    v_fma_mix_f32 v182, v182, v32, v36 op_sel_hi:[1,0,0]
    v_or3_b32 v25, v25, v179, v183
    v_fma_mix_f32 v179, v179, v33, v37 op_sel_hi:[1,0,0]
    v_fma_mix_f32 v183, v183, v33, v37 op_sel_hi:[1,0,0]
    v_cvt_pk_bf16_f32 v64, v176, v180
    v_cvt_pk_bf16_f32 v68, v177, v181
    v_cvt_pk_bf16_f32 v72, v178, v182
    v_cvt_pk_bf16_f32 v76, v179, v183
    s_waitcnt vmcnt(9)
    buffer_load_dwordx4 v11, s[8:11], s57 offen offset:1024 lds
    s_add_u32 m0, s43, 24576
    v_add_u32_e32 v11, s77, v10
    buffer_load_dwordx4 v11, s[8:11], s50 offen lds
    v_or3_b32 v24, v24, v184, v188
    v_fma_mix_f32 v184, v184, v30, v34 op_sel_hi:[1,0,0]
    v_fma_mix_f32 v188, v188, v30, v34 op_sel_hi:[1,0,0]
    v_or3_b32 v25, v25, v185, v189
    v_fma_mix_f32 v185, v185, v31, v35 op_sel_hi:[1,0,0]
    v_fma_mix_f32 v189, v189, v31, v35 op_sel_hi:[1,0,0]
    v_or3_b32 v24, v24, v186, v190
    v_fma_mix_f32 v186, v186, v32, v36 op_sel_hi:[1,0,0]
    v_fma_mix_f32 v190, v190, v32, v36 op_sel_hi:[1,0,0]
    v_or3_b32 v25, v25, v187, v191
    v_fma_mix_f32 v187, v187, v33, v37 op_sel_hi:[1,0,0]
    v_fma_mix_f32 v191, v191, v33, v37 op_sel_hi:[1,0,0]
    v_cvt_pk_bf16_f32 v65, v184, v188
    v_cvt_pk_bf16_f32 v69, v185, v189
    v_cvt_pk_bf16_f32 v73, v186, v190
    v_cvt_pk_bf16_f32 v77, v187, v191
    s_waitcnt vmcnt(9)
    buffer_load_dwordx4 v11, s[8:11], s55 offen offset:1024 lds
    s_mul_i32 s35, s77, 9216
    v_add_u32_e32 v8, s35, v9
    buffer_load_dwordx4 v[208:211], v8, s[12:15], s60 offen
    v_or3_b32 v24, v24, v192, v196
    v_fma_mix_f32 v192, v192, v30, v34 op_sel_hi:[1,0,0]
    v_fma_mix_f32 v196, v196, v30, v34 op_sel_hi:[1,0,0]
    v_or3_b32 v25, v25, v193, v197
    v_fma_mix_f32 v193, v193, v31, v35 op_sel_hi:[1,0,0]
    v_fma_mix_f32 v197, v197, v31, v35 op_sel_hi:[1,0,0]
    v_or3_b32 v24, v24, v194, v198
    v_fma_mix_f32 v194, v194, v32, v36 op_sel_hi:[1,0,0]
    v_fma_mix_f32 v198, v198, v32, v36 op_sel_hi:[1,0,0]
    v_or3_b32 v25, v25, v195, v199
    v_fma_mix_f32 v195, v195, v33, v37 op_sel_hi:[1,0,0]
    v_fma_mix_f32 v199, v199, v33, v37 op_sel_hi:[1,0,0]
    v_cvt_pk_bf16_f32 v66, v192, v196
    v_cvt_pk_bf16_f32 v70, v193, v197
    v_cvt_pk_bf16_f32 v74, v194, v198
    v_cvt_pk_bf16_f32 v78, v195, v199
    s_waitcnt vmcnt(9)
    buffer_load_dwordx4 v[212:215], v8, s[12:15], s61 offen
    buffer_load_dwordx4 v[216:219], v8, s[12:15], s62 offen
    v_or3_b32 v24, v24, v200, v204
    v_fma_mix_f32 v200, v200, v30, v34 op_sel_hi:[1,0,0]
    v_fma_mix_f32 v204, v204, v30, v34 op_sel_hi:[1,0,0]
    v_cvt_pk_bf16_f32 v67, v200, v204
    ds_write_b128 v20, v[64:67] offset:0
    v_or3_b32 v25, v25, v201, v205
    v_fma_mix_f32 v201, v201, v31, v35 op_sel_hi:[1,0,0]
    v_fma_mix_f32 v205, v205, v31, v35 op_sel_hi:[1,0,0]
    v_cvt_pk_bf16_f32 v71, v201, v205
    ds_write_b128 v20, v[68:71] offset:1024
    v_or3_b32 v24, v24, v202, v206
    v_fma_mix_f32 v202, v202, v32, v36 op_sel_hi:[1,0,0]
    v_fma_mix_f32 v206, v206, v32, v36 op_sel_hi:[1,0,0]
    v_cvt_pk_bf16_f32 v75, v202, v206
    ds_write_b128 v20, v[72:75] offset:2048
    v_or3_b32 v25, v25, v203, v207
    v_fma_mix_f32 v203, v203, v33, v37 op_sel_hi:[1,0,0]
    v_fma_mix_f32 v207, v207, v33, v37 op_sel_hi:[1,0,0]
    v_cvt_pk_bf16_f32 v79, v203, v207
    ds_write_b128 v20, v[76:79] offset:3072
    buffer_load_dwordx4 v[220:223], v8, s[12:15], s63 offen
    v_mul_f32_e32 v3, s68, v44
    v_rndne_f32_e32 v7, v3
    v_cmp_neq_f32_e32 vcc, v3, v7
    s_or_b64 s[46:47], s[46:47], vcc
    v_cmp_nle_f32_e64 vcc, |v44|, s69
    s_or_b64 s[46:47], s[46:47], vcc
    v_and_b32_e32 v3, s71, v44
    v_add_u32_e32 v3, -1, v3
    buffer_load_dwordx4 v[224:227], v8, s[12:15], s64 offen
    v_cmp_gt_u32_e32 vcc, s70, v3
    s_or_b64 s[46:47], s[46:47], vcc
    v_and_b32_e32 v3, s71, v40
    v_cmp_le_u32_e32 vcc, s72, v3
    s_or_b64 s[46:47], s[46:47], vcc
    v_add_u32_e32 v3, -1, v3
    v_cmp_gt_u32_e32 vcc, s70, v3
    s_or_b64 s[46:47], s[46:47], vcc
    buffer_load_dwordx4 v[228:231], v8, s[12:15], s65 offen
    v_mul_f32_e32 v3, s68, v45
    v_rndne_f32_e32 v7, v3
    v_cmp_neq_f32_e32 vcc, v3, v7
    s_or_b64 s[46:47], s[46:47], vcc
    v_cmp_nle_f32_e64 vcc, |v45|, s69
    s_or_b64 s[46:47], s[46:47], vcc
    v_and_b32_e32 v3, s71, v45
    v_add_u32_e32 v3, -1, v3
    buffer_load_dwordx4 v[232:235], v8, s[12:15], s66 offen
    v_cmp_gt_u32_e32 vcc, s70, v3
    s_or_b64 s[46:47], s[46:47], vcc
    v_and_b32_e32 v3, s71, v41
    v_cmp_le_u32_e32 vcc, s72, v3
    s_or_b64 s[46:47], s[46:47], vcc
    v_add_u32_e32 v3, -1, v3
    v_cmp_gt_u32_e32 vcc, s70, v3
    s_or_b64 s[46:47], s[46:47], vcc
    buffer_load_dwordx4 v[236:239], v8, s[12:15], s67 offen
    v_mul_f32_e32 v3, s68, v46
    s_add_u32 m0, s43, 32768
    v_rndne_f32_e32 v7, v3
    v_cmp_neq_f32_e32 vcc, v3, v7
    s_or_b64 s[46:47], s[46:47], vcc
    v_cmp_nle_f32_e64 vcc, |v46|, s69
    s_or_b64 s[46:47], s[46:47], vcc
    v_and_b32_e32 v3, s71, v46
    buffer_load_dwordx4 v11, s[8:11], s51 offen lds
    v_add_u32_e32 v3, -1, v3
    v_cmp_gt_u32_e32 vcc, s70, v3
    s_or_b64 s[46:47], s[46:47], vcc
    v_and_b32_e32 v3, s71, v42
    v_cmp_le_u32_e32 vcc, s72, v3
    s_or_b64 s[46:47], s[46:47], vcc
    v_add_u32_e32 v3, -1, v3
    v_cmp_gt_u32_e32 vcc, s70, v3
    buffer_load_dwordx4 v11, s[8:11], s56 offen offset:1024 lds
    s_or_b64 s[46:47], s[46:47], vcc
    s_add_u32 m0, s43, 40960
    v_mul_f32_e32 v3, s68, v47
    v_rndne_f32_e32 v7, v3
    v_cmp_neq_f32_e32 vcc, v3, v7
    s_or_b64 s[46:47], s[46:47], vcc
    v_cmp_nle_f32_e64 vcc, |v47|, s69
    s_or_b64 s[46:47], s[46:47], vcc
    buffer_load_dwordx4 v11, s[8:11], s52 offen lds
    v_and_b32_e32 v3, s71, v47
    v_add_u32_e32 v3, -1, v3
    v_cmp_gt_u32_e32 vcc, s70, v3
    s_or_b64 s[46:47], s[46:47], vcc
    v_and_b32_e32 v3, s71, v43
    v_cmp_le_u32_e32 vcc, s72, v3
    s_or_b64 s[46:47], s[46:47], vcc
    v_add_u32_e32 v3, -1, v3
    v_cmp_gt_u32_e32 vcc, s70, v3
    s_or_b64 s[46:47], s[46:47], vcc
    s_waitcnt vmcnt(11) lgkmcnt(0)
    s_barrier
    ds_read_b128 a[0:3], v21 offset:0
    ds_read_b128 v[40:43], v12 offset:0
    s_waitcnt vmcnt(9)
    v_or3_b32 v24, v24, v208, v212
    v_fma_mix_f32 v208, v208, v30, v34 op_sel_hi:[1,0,0]
    v_fma_mix_f32 v212, v212, v30, v34 op_sel_hi:[1,0,0]
    v_or3_b32 v25, v25, v209, v213
    ds_read_b128 a[4:7], v21 offset:1024
    ds_read_b128 v[44:47], v12 offset:4096
    v_fma_mix_f32 v209, v209, v31, v35 op_sel_hi:[1,0,0]
    v_fma_mix_f32 v213, v213, v31, v35 op_sel_hi:[1,0,0]
    v_or3_b32 v24, v24, v210, v214
    v_fma_mix_f32 v210, v210, v32, v36 op_sel_hi:[1,0,0]
    v_fma_mix_f32 v214, v214, v32, v36 op_sel_hi:[1,0,0]
    ds_read_b128 a[8:11], v21 offset:2048
    ds_read_b128 v[48:51], v13 offset:0
    v_or3_b32 v25, v25, v211, v215
    v_fma_mix_f32 v211, v211, v33, v37 op_sel_hi:[1,0,0]
    v_fma_mix_f32 v215, v215, v33, v37 op_sel_hi:[1,0,0]
    v_cvt_pk_bf16_f32 v64, v208, v212
    v_cvt_pk_bf16_f32 v68, v209, v213
    ds_read_b128 a[12:15], v21 offset:3072
    ds_read_b128 v[52:55], v13 offset:4096
    buffer_load_dwordx4 v11, s[8:11], s57 offen offset:1024 lds
    v_cvt_pk_bf16_f32 v72, v210, v214
    v_cvt_pk_bf16_f32 v76, v211, v215
    s_waitcnt vmcnt(8)
    v_or3_b32 v24, v24, v216, v220
    ds_read_b128 a[16:19], v21 offset:4096
    ds_read_b128 v[56:59], v12 offset:8192
    v_fma_mix_f32 v216, v216, v30, v34 op_sel_hi:[1,0,0]
    v_fma_mix_f32 v220, v220, v30, v34 op_sel_hi:[1,0,0]
    s_add_u32 m0, s43, 49152
    v_add_u32_e32 v11, s78, v10
    ds_read_b128 a[20:23], v21 offset:5120
    ds_read_b128 v[60:63], v12 offset:12288
    buffer_load_dwordx4 v11, s[8:11], s50 offen lds
    v_or3_b32 v25, v25, v217, v221
    v_fma_mix_f32 v217, v217, v31, v35 op_sel_hi:[1,0,0]
    v_fma_mix_f32 v221, v221, v31, v35 op_sel_hi:[1,0,0]
    s_waitcnt lgkmcnt(6)
    ds_read_b128 a[24:27], v21 offset:6144
    buffer_load_dwordx4 v11, s[8:11], s55 offen offset:1024 lds
    v_or3_b32 v24, v24, v218, v222
    v_mfma_f32_16x16x32_bf16 v[80:83], v[40:43], a[0:3], 0
    v_fma_mix_f32 v218, v218, v32, v36 op_sel_hi:[1,0,0]
    s_mul_i32 s35, s78, 9216
    v_mfma_f32_16x16x32_bf16 v[84:87], v[40:43], a[4:7], 0
    v_add_u32_e32 v8, s35, v9
    s_waitcnt lgkmcnt(5)
    v_mfma_f32_16x16x32_bf16 v[88:91], v[40:43], a[8:11], 0
    ds_read_b128 a[28:31], v21 offset:7168
    v_mfma_f32_16x16x32_bf16 v[92:95], v[40:43], a[12:15], 0
    ds_read_b128 v[40:43], v13 offset:8192
    buffer_load_dwordx4 v[240:243], v8, s[12:15], s60 offen
    v_fma_mix_f32 v222, v222, v32, v36 op_sel_hi:[1,0,0]
    v_or3_b32 v25, v25, v219, v223
    v_fma_mix_f32 v219, v219, v33, v37 op_sel_hi:[1,0,0]
    v_mfma_f32_16x16x32_bf16 v[96:99], v[44:47], a[0:3], 0
    buffer_load_dwordx4 v[244:247], v8, s[12:15], s61 offen
    v_fma_mix_f32 v223, v223, v33, v37 op_sel_hi:[1,0,0]
    v_mfma_f32_16x16x32_bf16 v[100:103], v[44:47], a[4:7], 0
    v_cvt_pk_bf16_f32 v65, v216, v220
    v_cvt_pk_bf16_f32 v69, v217, v221
    v_mfma_f32_16x16x32_bf16 v[104:107], v[44:47], a[8:11], 0
    v_cvt_pk_bf16_f32 v73, v218, v222
    v_cvt_pk_bf16_f32 v77, v219, v223
    v_mfma_f32_16x16x32_bf16 v[108:111], v[44:47], a[12:15], 0
    ds_read_b128 v[44:47], v13 offset:12288
    buffer_load_dwordx4 v[248:251], v8, s[12:15], s62 offen
    s_waitcnt vmcnt(11)
    v_or3_b32 v24, v24, v224, v228
    v_fma_mix_f32 v224, v224, v30, v34 op_sel_hi:[1,0,0]
    s_waitcnt lgkmcnt(3)
    v_mfma_f32_16x16x32_bf16 v[80:83], v[48:51], a[16:19], v[80:83]
    buffer_load_dwordx4 v[252:255], v8, s[12:15], s63 offen
    v_fma_mix_f32 v228, v228, v30, v34 op_sel_hi:[1,0,0]
    v_mfma_f32_16x16x32_bf16 v[84:87], v[48:51], a[20:23], v[84:87]
    s_waitcnt vmcnt(10)
    v_or3_b32 v24, v24, v232, v236
    v_fma_mix_f32 v232, v232, v30, v34 op_sel_hi:[1,0,0]
    s_waitcnt lgkmcnt(1)
    v_mfma_f32_16x16x32_bf16 v[88:91], v[48:51], a[24:27], v[88:91]
    v_mfma_f32_16x16x32_bf16 v[92:95], v[48:51], a[28:31], v[92:95]
    ds_read_b128 v[48:51], v12 offset:16384
    buffer_load_dwordx4 v[176:179], v8, s[12:15], s64 offen
    v_fma_mix_f32 v236, v236, v30, v34 op_sel_hi:[1,0,0]
    v_cvt_pk_bf16_f32 v66, v224, v228
    v_cvt_pk_bf16_f32 v67, v232, v236
    v_or3_b32 v25, v25, v225, v229
    v_mfma_f32_16x16x32_bf16 v[96:99], v[52:55], a[16:19], v[96:99]
    ds_write_b128 v20, v[64:67] offset:16384
    v_fma_mix_f32 v225, v225, v31, v35 op_sel_hi:[1,0,0]
    v_mfma_f32_16x16x32_bf16 v[100:103], v[52:55], a[20:23], v[100:103]
    v_fma_mix_f32 v229, v229, v31, v35 op_sel_hi:[1,0,0]
    v_or3_b32 v25, v25, v233, v237
    v_mfma_f32_16x16x32_bf16 v[104:107], v[52:55], a[24:27], v[104:107]
    buffer_load_dwordx4 v[180:183], v8, s[12:15], s65 offen
    v_fma_mix_f32 v233, v233, v31, v35 op_sel_hi:[1,0,0]
    v_mfma_f32_16x16x32_bf16 v[108:111], v[52:55], a[28:31], v[108:111]
    v_fma_mix_f32 v237, v237, v31, v35 op_sel_hi:[1,0,0]
    v_cvt_pk_bf16_f32 v70, v225, v229
    v_cvt_pk_bf16_f32 v71, v233, v237
    v_mfma_f32_16x16x32_bf16 v[112:115], v[56:59], a[0:3], 0
    v_or3_b32 v24, v24, v226, v230
    ds_read_b128 v[52:55], v12 offset:20480
    v_mfma_f32_16x16x32_bf16 v[116:119], v[56:59], a[4:7], 0
    buffer_load_dwordx4 v[184:187], v8, s[12:15], s66 offen
    v_fma_mix_f32 v226, v226, v32, v36 op_sel_hi:[1,0,0]
    v_mfma_f32_16x16x32_bf16 v[120:123], v[56:59], a[8:11], 0
    v_fma_mix_f32 v230, v230, v32, v36 op_sel_hi:[1,0,0]
    v_or3_b32 v24, v24, v234, v238
    v_mfma_f32_16x16x32_bf16 v[124:127], v[56:59], a[12:15], 0
    ds_write_b128 v20, v[68:71] offset:17408
    v_fma_mix_f32 v234, v234, v32, v36 op_sel_hi:[1,0,0]
    v_mfma_f32_16x16x32_bf16 v[128:131], v[60:63], a[0:3], 0
    v_fma_mix_f32 v238, v238, v32, v36 op_sel_hi:[1,0,0]
    v_cvt_pk_bf16_f32 v74, v226, v230
    v_mfma_f32_16x16x32_bf16 v[132:135], v[60:63], a[4:7], 0
    buffer_load_dwordx4 v[188:191], v8, s[12:15], s67 offen
    s_add_u32 m0, s43, 57344
    v_mfma_f32_16x16x32_bf16 v[136:139], v[60:63], a[8:11], 0
    v_cvt_pk_bf16_f32 v75, v234, v238
    ds_read_b128 v[56:59], v13 offset:16384
    v_mfma_f32_16x16x32_bf16 v[140:143], v[60:63], a[12:15], 0
    ds_read_b128 v[60:63], v13 offset:20480
    buffer_load_dwordx4 v11, s[8:11], s51 offen lds
    v_or3_b32 v25, v25, v227, v231
    v_fma_mix_f32 v227, v227, v33, v37 op_sel_hi:[1,0,0]
    v_fma_mix_f32 v231, v231, v33, v37 op_sel_hi:[1,0,0]
    v_mfma_f32_16x16x32_bf16 v[112:115], v[40:43], a[16:19], v[112:115]
    ds_write_b128 v20, v[72:75] offset:18432
    v_or3_b32 v25, v25, v235, v239
    v_mfma_f32_16x16x32_bf16 v[116:119], v[40:43], a[20:23], v[116:119]
    v_fma_mix_f32 v235, v235, v33, v37 op_sel_hi:[1,0,0]
    v_fma_mix_f32 v239, v239, v33, v37 op_sel_hi:[1,0,0]
    v_mfma_f32_16x16x32_bf16 v[120:123], v[40:43], a[24:27], v[120:123]
    buffer_load_dwordx4 v11, s[8:11], s56 offen offset:1024 lds
    s_add_u32 m0, s43, 65536
    v_mfma_f32_16x16x32_bf16 v[124:127], v[40:43], a[28:31], v[124:127]
    v_cvt_pk_bf16_f32 v78, v227, v231
    v_cvt_pk_bf16_f32 v79, v235, v239
    s_waitcnt vmcnt(8) lgkmcnt(3)
    v_mfma_f32_16x16x32_bf16 v[128:131], v[44:47], a[16:19], v[128:131]
    ds_read_b128 v[40:43], v12 offset:24576
    buffer_load_dwordx4 v11, s[8:11], s52 offen lds
    v_mfma_f32_16x16x32_bf16 v[132:135], v[44:47], a[20:23], v[132:135]
    v_or3_b32 v24, v24, v240, v244
    v_fma_mix_f32 v240, v240, v30, v34 op_sel_hi:[1,0,0]
    v_fma_mix_f32 v244, v244, v30, v34 op_sel_hi:[1,0,0]
    v_or3_b32 v25, v25, v241, v245
    v_mfma_f32_16x16x32_bf16 v[136:139], v[44:47], a[24:27], v[136:139]
    ds_write_b128 v20, v[76:79] offset:19456
    v_fma_mix_f32 v241, v241, v31, v35 op_sel_hi:[1,0,0]
    v_mfma_f32_16x16x32_bf16 v[140:143], v[44:47], a[28:31], v[140:143]
    v_fma_mix_f32 v245, v245, v31, v35 op_sel_hi:[1,0,0]
    v_or3_b32 v24, v24, v242, v246
    v_mfma_f32_16x16x32_bf16 v[144:147], v[48:51], a[0:3], 0
    buffer_load_dwordx4 v11, s[8:11], s57 offen offset:1024 lds
    v_fma_mix_f32 v242, v242, v32, v36 op_sel_hi:[1,0,0]
    v_mfma_f32_16x16x32_bf16 v[148:151], v[48:51], a[4:7], 0
    v_fma_mix_f32 v246, v246, v32, v36 op_sel_hi:[1,0,0]
    s_add_u32 m0, s43, 73728
    v_add_u32_e32 v11, s79, v10
    v_mfma_f32_16x16x32_bf16 v[152:155], v[48:51], a[8:11], 0
    v_or3_b32 v25, v25, v243, v247
    ds_read_b128 v[44:47], v12 offset:28672
    v_mfma_f32_16x16x32_bf16 v[156:159], v[48:51], a[12:15], 0
    ds_read_b128 v[48:51], v13 offset:24576
    buffer_load_dwordx4 v11, s[8:11], s50 offen lds
    v_fma_mix_f32 v243, v243, v33, v37 op_sel_hi:[1,0,0]
    v_mfma_f32_16x16x32_bf16 v[160:163], v[52:55], a[0:3], 0
    v_fma_mix_f32 v247, v247, v33, v37 op_sel_hi:[1,0,0]
    v_cvt_pk_bf16_f32 v64, v240, v244
    v_mfma_f32_16x16x32_bf16 v[164:167], v[52:55], a[4:7], 0
    s_waitcnt lgkmcnt(2)
    s_barrier
    v_mfma_f32_16x16x32_bf16 v[168:171], v[52:55], a[8:11], 0
    ds_read_b128 a[32:35], v21 offset:16384
    v_mfma_f32_16x16x32_bf16 v[172:175], v[52:55], a[12:15], 0
    ds_read_b128 v[52:55], v13 offset:28672
    buffer_load_dwordx4 v11, s[8:11], s55 offen offset:1024 lds
    v_cvt_pk_bf16_f32 v68, v241, v245
    v_cvt_pk_bf16_f32 v72, v242, v246
    s_mul_i32 s35, s79, 9216
    v_add_u32_e32 v8, s35, v9
    v_mfma_f32_16x16x32_bf16 v[144:147], v[56:59], a[16:19], v[144:147]
    ds_read_b128 a[36:39], v21 offset:17408
    buffer_load_dwordx4 v[192:195], v8, s[12:15], s60 offen
    v_mfma_f32_16x16x32_bf16 v[148:151], v[56:59], a[20:23], v[148:151]
    v_cvt_pk_bf16_f32 v76, v243, v247
    s_waitcnt vmcnt(11)
    v_or3_b32 v24, v24, v248, v252
    v_mfma_f32_16x16x32_bf16 v[152:155], v[56:59], a[24:27], v[152:155]
    v_fma_mix_f32 v248, v248, v30, v34 op_sel_hi:[1,0,0]
    ds_read_b128 a[40:43], v21 offset:18432
    v_mfma_f32_16x16x32_bf16 v[156:159], v[56:59], a[28:31], v[156:159]
    ds_read_b128 v[56:59], v12 offset:32768
    v_fma_mix_f32 v252, v252, v30, v34 op_sel_hi:[1,0,0]
    v_or3_b32 v25, v25, v249, v253
    v_fma_mix_f32 v249, v249, v31, v35 op_sel_hi:[1,0,0]
    v_fma_mix_f32 v253, v253, v31, v35 op_sel_hi:[1,0,0]
    v_mfma_f32_16x16x32_bf16 v[160:163], v[60:63], a[16:19], v[160:163]
    ds_read_b128 a[44:47], v21 offset:19456
    buffer_load_dwordx4 v[196:199], v8, s[12:15], s61 offen
    v_mfma_f32_16x16x32_bf16 v[164:167], v[60:63], a[20:23], v[164:167]
    v_or3_b32 v24, v24, v250, v254
    v_fma_mix_f32 v250, v250, v32, v36 op_sel_hi:[1,0,0]
    v_mfma_f32_16x16x32_bf16 v[168:171], v[60:63], a[24:27], v[168:171]
    v_fma_mix_f32 v254, v254, v32, v36 op_sel_hi:[1,0,0]
    ds_read_b128 a[48:51], v21 offset:20480
    v_mfma_f32_16x16x32_bf16 v[172:175], v[60:63], a[28:31], v[172:175]
    ds_read_b128 v[60:63], v12 offset:36864
    v_or3_b32 v25, v25, v251, v255
    v_fma_mix_f32 v251, v251, v33, v37 op_sel_hi:[1,0,0]
    s_waitcnt lgkmcnt(5)
    v_mfma_f32_16x16x32_bf16 v[80:83], v[40:43], a[32:35], v[80:83]
    ds_read_b128 a[52:55], v21 offset:21504
    buffer_load_dwordx4 v[200:203], v8, s[12:15], s62 offen
    v_mfma_f32_16x16x32_bf16 v[84:87], v[40:43], a[36:39], v[84:87]
L_tL0:
    s_cbranch_execz L_retL
    v_fma_mix_f32 v255, v255, v33, v37 op_sel_hi:[1,0,0]
    v_cvt_pk_bf16_f32 v65, v248, v252
    s_waitcnt lgkmcnt(3)
    v_mfma_f32_16x16x32_bf16 v[88:91], v[40:43], a[40:43], v[88:91]
    ds_read_b128 a[56:59], v21 offset:22528
    v_mfma_f32_16x16x32_bf16 v[92:95], v[40:43], a[44:47], v[92:95]
    ds_read_b128 v[40:43], v13 offset:32768
    v_cvt_pk_bf16_f32 v69, v249, v253
    v_cvt_pk_bf16_f32 v73, v250, v254
    v_cvt_pk_bf16_f32 v77, v251, v255
    v_mfma_f32_16x16x32_bf16 v[96:99], v[44:47], a[32:35], v[96:99]
    ds_read_b128 a[60:63], v21 offset:23552
    buffer_load_dwordx4 v[204:207], v8, s[12:15], s63 offen
    v_mfma_f32_16x16x32_bf16 v[100:103], v[44:47], a[36:39], v[100:103]
    s_waitcnt vmcnt(12)
    v_or3_b32 v24, v24, v176, v180
    v_mfma_f32_16x16x32_bf16 v[104:107], v[44:47], a[40:43], v[104:107]
    v_fma_mix_f32 v176, v176, v30, v34 op_sel_hi:[1,0,0]
    v_fma_mix_f32 v180, v180, v30, v34 op_sel_hi:[1,0,0]
    v_mfma_f32_16x16x32_bf16 v[108:111], v[44:47], a[44:47], v[108:111]
    ds_read_b128 v[44:47], v13 offset:36864
    buffer_load_dwordx4 v[208:211], v8, s[12:15], s64 offen
    s_waitcnt vmcnt(11)
    v_or3_b32 v24, v24, v184, v188
    v_fma_mix_f32 v184, v184, v30, v34 op_sel_hi:[1,0,0]
    s_waitcnt lgkmcnt(4)
    v_mfma_f32_16x16x32_bf16 v[80:83], v[48:51], a[48:51], v[80:83]
    v_fma_mix_f32 v188, v188, v30, v34 op_sel_hi:[1,0,0]
    v_cvt_pk_bf16_f32 v66, v176, v180
    v_mfma_f32_16x16x32_bf16 v[84:87], v[48:51], a[52:55], v[84:87]
    v_cvt_pk_bf16_f32 v67, v184, v188
    v_or3_b32 v25, v25, v177, v181
    s_waitcnt lgkmcnt(1)
    v_mfma_f32_16x16x32_bf16 v[88:91], v[48:51], a[56:59], v[88:91]
    v_mfma_f32_16x16x32_bf16 v[92:95], v[48:51], a[60:63], v[92:95]
    ds_read_b128 v[48:51], v12 offset:40960
    buffer_load_dwordx4 v[212:215], v8, s[12:15], s65 offen
    v_fma_mix_f32 v177, v177, v31, v35 op_sel_hi:[1,0,0]
    v_fma_mix_f32 v181, v181, v31, v35 op_sel_hi:[1,0,0]
    v_mfma_f32_16x16x32_bf16 v[96:99], v[52:55], a[48:51], v[96:99]
    v_or3_b32 v25, v25, v185, v189
    v_fma_mix_f32 v185, v185, v31, v35 op_sel_hi:[1,0,0]
    v_mfma_f32_16x16x32_bf16 v[100:103], v[52:55], a[52:55], v[100:103]
    ds_write_b128 v20, v[64:67] offset:0
    v_mfma_f32_16x16x32_bf16 v[104:107], v[52:55], a[56:59], v[104:107]
    v_fma_mix_f32 v189, v189, v31, v35 op_sel_hi:[1,0,0]
    v_cvt_pk_bf16_f32 v70, v177, v181
    v_mfma_f32_16x16x32_bf16 v[108:111], v[52:55], a[60:63], v[108:111]
    v_cvt_pk_bf16_f32 v71, v185, v189
    buffer_load_dwordx4 v[216:219], v8, s[12:15], s66 offen
    v_mfma_f32_16x16x32_bf16 v[112:115], v[56:59], a[32:35], v[112:115]
    v_or3_b32 v24, v24, v178, v182
    ds_read_b128 v[52:55], v12 offset:45056
    v_mfma_f32_16x16x32_bf16 v[116:119], v[56:59], a[36:39], v[116:119]
    v_fma_mix_f32 v178, v178, v32, v36 op_sel_hi:[1,0,0]
    v_fma_mix_f32 v182, v182, v32, v36 op_sel_hi:[1,0,0]
    v_mfma_f32_16x16x32_bf16 v[120:123], v[56:59], a[40:43], v[120:123]
    v_or3_b32 v24, v24, v186, v190
    v_fma_mix_f32 v186, v186, v32, v36 op_sel_hi:[1,0,0]
    v_mfma_f32_16x16x32_bf16 v[124:127], v[56:59], a[44:47], v[124:127]
    ds_write_b128 v20, v[68:71] offset:1024
    v_fma_mix_f32 v190, v190, v32, v36 op_sel_hi:[1,0,0]
    v_mfma_f32_16x16x32_bf16 v[128:131], v[60:63], a[32:35], v[128:131]
    v_cvt_pk_bf16_f32 v74, v178, v182
    v_cvt_pk_bf16_f32 v75, v186, v190
    v_mfma_f32_16x16x32_bf16 v[132:135], v[60:63], a[36:39], v[132:135]
    buffer_load_dwordx4 v[220:223], v8, s[12:15], s67 offen
    s_add_u32 m0, s43, 81920
    v_mfma_f32_16x16x32_bf16 v[136:139], v[60:63], a[40:43], v[136:139]
    v_or3_b32 v25, v25, v179, v183
    ds_read_b128 v[56:59], v13 offset:40960
    v_mfma_f32_16x16x32_bf16 v[140:143], v[60:63], a[44:47], v[140:143]
    ds_read_b128 v[60:63], v13 offset:45056
    buffer_load_dwordx4 v11, s[8:11], s51 offen lds
    v_fma_mix_f32 v179, v179, v33, v37 op_sel_hi:[1,0,0]
    v_fma_mix_f32 v183, v183, v33, v37 op_sel_hi:[1,0,0]
    v_or3_b32 v25, v25, v187, v191
    v_mfma_f32_16x16x32_bf16 v[112:115], v[40:43], a[48:51], v[112:115]
    ds_write_b128 v20, v[72:75] offset:2048
    v_fma_mix_f32 v187, v187, v33, v37 op_sel_hi:[1,0,0]
    v_mfma_f32_16x16x32_bf16 v[116:119], v[40:43], a[52:55], v[116:119]
    v_fma_mix_f32 v191, v191, v33, v37 op_sel_hi:[1,0,0]
    v_cvt_pk_bf16_f32 v78, v179, v183
    v_mfma_f32_16x16x32_bf16 v[120:123], v[40:43], a[56:59], v[120:123]
    buffer_load_dwordx4 v11, s[8:11], s56 offen offset:1024 lds
    s_add_u32 m0, s43, 90112
    v_mfma_f32_16x16x32_bf16 v[124:127], v[40:43], a[60:63], v[124:127]
    v_cvt_pk_bf16_f32 v79, v187, v191
    s_waitcnt vmcnt(8)
    v_or3_b32 v24, v24, v192, v196
    s_waitcnt lgkmcnt(3)
    v_mfma_f32_16x16x32_bf16 v[128:131], v[44:47], a[48:51], v[128:131]
    ds_read_b128 v[40:43], v12 offset:49152
    buffer_load_dwordx4 v11, s[8:11], s52 offen lds
    v_mfma_f32_16x16x32_bf16 v[132:135], v[44:47], a[52:55], v[132:135]
    v_fma_mix_f32 v192, v192, v30, v34 op_sel_hi:[1,0,0]
    v_fma_mix_f32 v196, v196, v30, v34 op_sel_hi:[1,0,0]
    v_or3_b32 v25, v25, v193, v197
    v_fma_mix_f32 v193, v193, v31, v35 op_sel_hi:[1,0,0]
    v_mfma_f32_16x16x32_bf16 v[136:139], v[44:47], a[56:59], v[136:139]
    ds_write_b128 v20, v[76:79] offset:3072
    v_fma_mix_f32 v197, v197, v31, v35 op_sel_hi:[1,0,0]
    v_mfma_f32_16x16x32_bf16 v[140:143], v[44:47], a[60:63], v[140:143]
    v_or3_b32 v24, v24, v194, v198
    v_fma_mix_f32 v194, v194, v32, v36 op_sel_hi:[1,0,0]
    v_mfma_f32_16x16x32_bf16 v[144:147], v[48:51], a[32:35], v[144:147]
    buffer_load_dwordx4 v11, s[8:11], s57 offen offset:1024 lds
    s_add_u32 m0, s43, 98304
    v_mfma_f32_16x16x32_bf16 v[148:151], v[48:51], a[36:39], v[148:151]
    v_add_u32_e32 v11, s80, v10
    v_fma_mix_f32 v198, v198, v32, v36 op_sel_hi:[1,0,0]
    v_or3_b32 v25, v25, v195, v199
    v_mfma_f32_16x16x32_bf16 v[152:155], v[48:51], a[40:43], v[152:155]
    v_fma_mix_f32 v195, v195, v33, v37 op_sel_hi:[1,0,0]
    ds_read_b128 v[44:47], v12 offset:53248
    v_mfma_f32_16x16x32_bf16 v[156:159], v[48:51], a[44:47], v[156:159]
    ds_read_b128 v[48:51], v13 offset:49152
    buffer_load_dwordx4 v11, s[8:11], s50 offen lds
    v_fma_mix_f32 v199, v199, v33, v37 op_sel_hi:[1,0,0]
    v_mfma_f32_16x16x32_bf16 v[160:163], v[52:55], a[32:35], v[160:163]
    v_cvt_pk_bf16_f32 v64, v192, v196
    v_cvt_pk_bf16_f32 v68, v193, v197
    v_mfma_f32_16x16x32_bf16 v[164:167], v[52:55], a[36:39], v[164:167]
    s_waitcnt lgkmcnt(2)
    s_barrier
    v_mfma_f32_16x16x32_bf16 v[168:171], v[52:55], a[40:43], v[168:171]
    ds_read_b128 a[64:67], v21 offset:0
    v_mfma_f32_16x16x32_bf16 v[172:175], v[52:55], a[44:47], v[172:175]
    ds_read_b128 v[52:55], v13 offset:53248
    buffer_load_dwordx4 v11, s[8:11], s55 offen offset:1024 lds
    s_mul_i32 s35, s80, 9216
    v_add_u32_e32 v8, s35, v9
    v_cvt_pk_bf16_f32 v72, v194, v198
    v_mfma_f32_16x16x32_bf16 v[144:147], v[56:59], a[48:51], v[144:147]
    ds_read_b128 a[68:71], v21 offset:1024
    v_cvt_pk_bf16_f32 v76, v195, v199
    v_mfma_f32_16x16x32_bf16 v[148:151], v[56:59], a[52:55], v[148:151]
    s_waitcnt vmcnt(10)
    v_or3_b32 v24, v24, v200, v204
    v_fma_mix_f32 v200, v200, v30, v34 op_sel_hi:[1,0,0]
    v_mfma_f32_16x16x32_bf16 v[152:155], v[56:59], a[56:59], v[152:155]
    v_fma_mix_f32 v204, v204, v30, v34 op_sel_hi:[1,0,0]
    ds_read_b128 a[72:75], v21 offset:2048
    v_mfma_f32_16x16x32_bf16 v[156:159], v[56:59], a[60:63], v[156:159]
    ds_read_b128 v[56:59], v12 offset:57344
    buffer_load_dwordx4 v[224:227], v8, s[12:15], s60 offen
    v_or3_b32 v25, v25, v201, v205
    v_fma_mix_f32 v201, v201, v31, v35 op_sel_hi:[1,0,0]
    v_mfma_f32_16x16x32_bf16 v[160:163], v[60:63], a[48:51], v[160:163]
    v_fma_mix_f32 v205, v205, v31, v35 op_sel_hi:[1,0,0]
    ds_read_b128 a[76:79], v21 offset:3072
    v_mfma_f32_16x16x32_bf16 v[164:167], v[60:63], a[52:55], v[164:167]
    buffer_load_dwordx4 v[228:231], v8, s[12:15], s61 offen
    v_or3_b32 v24, v24, v202, v206
    v_mfma_f32_16x16x32_bf16 v[168:171], v[60:63], a[56:59], v[168:171]
    v_fma_mix_f32 v202, v202, v32, v36 op_sel_hi:[1,0,0]
    ds_read_b128 a[80:83], v21 offset:4096
    v_mfma_f32_16x16x32_bf16 v[172:175], v[60:63], a[60:63], v[172:175]
    ds_read_b128 v[60:63], v12 offset:61440
    v_fma_mix_f32 v206, v206, v32, v36 op_sel_hi:[1,0,0]
    v_or3_b32 v25, v25, v203, v207
    v_fma_mix_f32 v203, v203, v33, v37 op_sel_hi:[1,0,0]
    s_waitcnt lgkmcnt(5)
    v_mfma_f32_16x16x32_bf16 v[80:83], v[40:43], a[64:67], v[80:83]
    ds_read_b128 a[84:87], v21 offset:5120
    buffer_load_dwordx4 v[232:235], v8, s[12:15], s62 offen
    v_mfma_f32_16x16x32_bf16 v[84:87], v[40:43], a[68:71], v[84:87]
    v_fma_mix_f32 v207, v207, v33, v37 op_sel_hi:[1,0,0]
    v_cvt_pk_bf16_f32 v65, v200, v204
    s_waitcnt lgkmcnt(3)
    v_mfma_f32_16x16x32_bf16 v[88:91], v[40:43], a[72:75], v[88:91]
    ds_read_b128 a[88:91], v21 offset:6144
    v_mfma_f32_16x16x32_bf16 v[92:95], v[40:43], a[76:79], v[92:95]
    ds_read_b128 v[40:43], v13 offset:57344
    v_cvt_pk_bf16_f32 v69, v201, v205
    v_cvt_pk_bf16_f32 v73, v202, v206
    v_cvt_pk_bf16_f32 v77, v203, v207
    s_waitcnt vmcnt(11)
    v_mfma_f32_16x16x32_bf16 v[96:99], v[44:47], a[64:67], v[96:99]
    ds_read_b128 a[92:95], v21 offset:7168
    buffer_load_dwordx4 v[236:239], v8, s[12:15], s63 offen
    v_mfma_f32_16x16x32_bf16 v[100:103], v[44:47], a[68:71], v[100:103]
    v_or3_b32 v24, v24, v208, v212
    v_fma_mix_f32 v208, v208, v30, v34 op_sel_hi:[1,0,0]
    v_mfma_f32_16x16x32_bf16 v[104:107], v[44:47], a[72:75], v[104:107]
    v_fma_mix_f32 v212, v212, v30, v34 op_sel_hi:[1,0,0]
    s_waitcnt vmcnt(10)
    v_mfma_f32_16x16x32_bf16 v[108:111], v[44:47], a[76:79], v[108:111]
    ds_read_b128 v[44:47], v13 offset:61440
    buffer_load_dwordx4 v[240:243], v8, s[12:15], s64 offen
    v_or3_b32 v24, v24, v216, v220
    v_fma_mix_f32 v216, v216, v30, v34 op_sel_hi:[1,0,0]
    v_fma_mix_f32 v220, v220, v30, v34 op_sel_hi:[1,0,0]
    s_waitcnt lgkmcnt(4)
    v_mfma_f32_16x16x32_bf16 v[80:83], v[48:51], a[80:83], v[80:83]
    v_cvt_pk_bf16_f32 v66, v208, v212
    v_cvt_pk_bf16_f32 v67, v216, v220
    v_mfma_f32_16x16x32_bf16 v[84:87], v[48:51], a[84:87], v[84:87]
    v_or3_b32 v25, v25, v209, v213
    s_waitcnt lgkmcnt(1)
    v_mfma_f32_16x16x32_bf16 v[88:91], v[48:51], a[88:91], v[88:91]
    v_mfma_f32_16x16x32_bf16 v[92:95], v[48:51], a[92:95], v[92:95]
    ds_read_b128 v[48:51], v14 offset:0
    buffer_load_dwordx4 v[244:247], v8, s[12:15], s65 offen
    v_fma_mix_f32 v209, v209, v31, v35 op_sel_hi:[1,0,0]
    v_fma_mix_f32 v213, v213, v31, v35 op_sel_hi:[1,0,0]
    v_or3_b32 v25, v25, v217, v221
    v_mfma_f32_16x16x32_bf16 v[96:99], v[52:55], a[80:83], v[96:99]
    ds_write_b128 v20, v[64:67] offset:16384
    v_mfma_f32_16x16x32_bf16 v[100:103], v[52:55], a[84:87], v[100:103]
    v_fma_mix_f32 v217, v217, v31, v35 op_sel_hi:[1,0,0]
    v_fma_mix_f32 v221, v221, v31, v35 op_sel_hi:[1,0,0]
    v_mfma_f32_16x16x32_bf16 v[104:107], v[52:55], a[88:91], v[104:107]
    v_cvt_pk_bf16_f32 v70, v209, v213
    buffer_load_dwordx4 v[248:251], v8, s[12:15], s66 offen
    v_mfma_f32_16x16x32_bf16 v[108:111], v[52:55], a[92:95], v[108:111]
    v_cvt_pk_bf16_f32 v71, v217, v221
    ds_read_b128 v[52:55], v14 offset:4096
    v_mfma_f32_16x16x32_bf16 v[112:115], v[56:59], a[64:67], v[112:115]
    v_or3_b32 v24, v24, v210, v214
    v_fma_mix_f32 v210, v210, v32, v36 op_sel_hi:[1,0,0]
    v_mfma_f32_16x16x32_bf16 v[116:119], v[56:59], a[68:71], v[116:119]
    v_fma_mix_f32 v214, v214, v32, v36 op_sel_hi:[1,0,0]
    v_or3_b32 v24, v24, v218, v222
    v_mfma_f32_16x16x32_bf16 v[120:123], v[56:59], a[72:75], v[120:123]
    ds_write_b128 v20, v[68:71] offset:17408
    v_mfma_f32_16x16x32_bf16 v[124:127], v[56:59], a[76:79], v[124:127]
    v_fma_mix_f32 v218, v218, v32, v36 op_sel_hi:[1,0,0]
    v_fma_mix_f32 v222, v222, v32, v36 op_sel_hi:[1,0,0]
    v_mfma_f32_16x16x32_bf16 v[128:131], v[60:63], a[64:67], v[128:131]
    v_cvt_pk_bf16_f32 v74, v210, v214
    buffer_load_dwordx4 v[252:255], v8, s[12:15], s67 offen
    v_mfma_f32_16x16x32_bf16 v[132:135], v[60:63], a[68:71], v[132:135]
    s_add_u32 m0, s43, 106496
    v_cvt_pk_bf16_f32 v75, v218, v222
    v_mfma_f32_16x16x32_bf16 v[136:139], v[60:63], a[72:75], v[136:139]
    v_or3_b32 v25, v25, v211, v215
    ds_read_b128 v[56:59], v15 offset:0
    v_mfma_f32_16x16x32_bf16 v[140:143], v[60:63], a[76:79], v[140:143]
    ds_read_b128 v[60:63], v15 offset:4096
    buffer_load_dwordx4 v11, s[8:11], s51 offen lds
    v_fma_mix_f32 v211, v211, v33, v37 op_sel_hi:[1,0,0]
    v_fma_mix_f32 v215, v215, v33, v37 op_sel_hi:[1,0,0]
    v_or3_b32 v25, v25, v219, v223
    v_mfma_f32_16x16x32_bf16 v[112:115], v[40:43], a[80:83], v[112:115]
    ds_write_b128 v20, v[72:75] offset:18432
    v_fma_mix_f32 v219, v219, v33, v37 op_sel_hi:[1,0,0]
    v_mfma_f32_16x16x32_bf16 v[116:119], v[40:43], a[84:87], v[116:119]
    v_fma_mix_f32 v223, v223, v33, v37 op_sel_hi:[1,0,0]
    v_cvt_pk_bf16_f32 v78, v211, v215
    v_mfma_f32_16x16x32_bf16 v[120:123], v[40:43], a[88:91], v[120:123]
    buffer_load_dwordx4 v11, s[8:11], s56 offen offset:1024 lds
    s_add_u32 m0, s43, 114688
    v_mfma_f32_16x16x32_bf16 v[124:127], v[40:43], a[92:95], v[124:127]
    v_cvt_pk_bf16_f32 v79, v219, v223
    s_waitcnt vmcnt(8)
    v_or3_b32 v24, v24, v224, v228
    s_waitcnt lgkmcnt(3)
    v_mfma_f32_16x16x32_bf16 v[128:131], v[44:47], a[80:83], v[128:131]
    ds_read_b128 v[40:43], v14 offset:8192
    buffer_load_dwordx4 v11, s[8:11], s52 offen lds
    v_mfma_f32_16x16x32_bf16 v[132:135], v[44:47], a[84:87], v[132:135]
    v_fma_mix_f32 v224, v224, v30, v34 op_sel_hi:[1,0,0]
    v_fma_mix_f32 v228, v228, v30, v34 op_sel_hi:[1,0,0]
    v_or3_b32 v25, v25, v225, v229
    v_fma_mix_f32 v225, v225, v31, v35 op_sel_hi:[1,0,0]
    v_mfma_f32_16x16x32_bf16 v[136:139], v[44:47], a[88:91], v[136:139]
    ds_write_b128 v20, v[76:79] offset:19456
    v_fma_mix_f32 v229, v229, v31, v35 op_sel_hi:[1,0,0]
    v_mfma_f32_16x16x32_bf16 v[140:143], v[44:47], a[92:95], v[140:143]
    v_or3_b32 v24, v24, v226, v230
    v_fma_mix_f32 v226, v226, v32, v36 op_sel_hi:[1,0,0]
    v_mfma_f32_16x16x32_bf16 v[144:147], v[48:51], a[64:67], v[144:147]
    buffer_load_dwordx4 v11, s[8:11], s57 offen offset:1024 lds
    v_fma_mix_f32 v230, v230, v32, v36 op_sel_hi:[1,0,0]
    v_mfma_f32_16x16x32_bf16 v[148:151], v[48:51], a[68:71], v[148:151]
    v_or3_b32 v25, v25, v227, v231
    s_add_u32 m0, s43, 122880
    v_add_u32_e32 v11, s81, v10
    v_mfma_f32_16x16x32_bf16 v[152:155], v[48:51], a[72:75], v[152:155]
    v_fma_mix_f32 v227, v227, v33, v37 op_sel_hi:[1,0,0]
    ds_read_b128 v[44:47], v14 offset:12288
    v_mfma_f32_16x16x32_bf16 v[156:159], v[48:51], a[76:79], v[156:159]
    ds_read_b128 v[48:51], v15 offset:8192
    buffer_load_dwordx4 v11, s[8:11], s50 offen lds
    v_fma_mix_f32 v231, v231, v33, v37 op_sel_hi:[1,0,0]
    v_mfma_f32_16x16x32_bf16 v[160:163], v[52:55], a[64:67], v[160:163]
    v_cvt_pk_bf16_f32 v64, v224, v228
    v_cvt_pk_bf16_f32 v68, v225, v229
    v_mfma_f32_16x16x32_bf16 v[164:167], v[52:55], a[68:71], v[164:167]
    s_waitcnt lgkmcnt(2)
    s_barrier
    v_mfma_f32_16x16x32_bf16 v[168:171], v[52:55], a[72:75], v[168:171]
    ds_read_b128 a[96:99], v21 offset:16384
    v_mfma_f32_16x16x32_bf16 v[172:175], v[52:55], a[76:79], v[172:175]
    ds_read_b128 v[52:55], v15 offset:12288
    buffer_load_dwordx4 v11, s[8:11], s55 offen offset:1024 lds
    v_cvt_pk_bf16_f32 v72, v226, v230
    s_mul_i32 s35, s81, 9216
    v_add_u32_e32 v8, s35, v9
    v_mfma_f32_16x16x32_bf16 v[144:147], v[56:59], a[80:83], v[144:147]
    ds_read_b128 a[100:103], v21 offset:17408
    v_cvt_pk_bf16_f32 v76, v227, v231
    v_mfma_f32_16x16x32_bf16 v[148:151], v[56:59], a[84:87], v[148:151]
    s_waitcnt vmcnt(10)
    v_or3_b32 v24, v24, v232, v236
    v_fma_mix_f32 v232, v232, v30, v34 op_sel_hi:[1,0,0]
    v_mfma_f32_16x16x32_bf16 v[152:155], v[56:59], a[88:91], v[152:155]
    v_fma_mix_f32 v236, v236, v30, v34 op_sel_hi:[1,0,0]
    ds_read_b128 a[104:107], v21 offset:18432
    v_mfma_f32_16x16x32_bf16 v[156:159], v[56:59], a[92:95], v[156:159]
    ds_read_b128 v[56:59], v14 offset:16384
    buffer_load_dwordx4 v[176:179], v8, s[12:15], s60 offen
    v_or3_b32 v25, v25, v233, v237
    v_fma_mix_f32 v233, v233, v31, v35 op_sel_hi:[1,0,0]
    v_fma_mix_f32 v237, v237, v31, v35 op_sel_hi:[1,0,0]
    v_mfma_f32_16x16x32_bf16 v[160:163], v[60:63], a[80:83], v[160:163]
    ds_read_b128 a[108:111], v21 offset:19456
    buffer_load_dwordx4 v[180:183], v8, s[12:15], s61 offen
    v_mfma_f32_16x16x32_bf16 v[164:167], v[60:63], a[84:87], v[164:167]
    v_or3_b32 v24, v24, v234, v238
    v_fma_mix_f32 v234, v234, v32, v36 op_sel_hi:[1,0,0]
    v_fma_mix_f32 v238, v238, v32, v36 op_sel_hi:[1,0,0]
    v_mfma_f32_16x16x32_bf16 v[168:171], v[60:63], a[88:91], v[168:171]
    v_or3_b32 v25, v25, v235, v239
    ds_read_b128 a[112:115], v21 offset:20480
    v_mfma_f32_16x16x32_bf16 v[172:175], v[60:63], a[92:95], v[172:175]
    ds_read_b128 v[60:63], v14 offset:20480
    v_fma_mix_f32 v235, v235, v33, v37 op_sel_hi:[1,0,0]
    v_fma_mix_f32 v239, v239, v33, v37 op_sel_hi:[1,0,0]
    s_waitcnt lgkmcnt(5)
    v_mfma_f32_16x16x32_bf16 v[80:83], v[40:43], a[96:99], v[80:83]
    ds_read_b128 a[116:119], v21 offset:21504
    buffer_load_dwordx4 v[184:187], v8, s[12:15], s62 offen
    v_mfma_f32_16x16x32_bf16 v[84:87], v[40:43], a[100:103], v[84:87]
    v_cvt_pk_bf16_f32 v65, v232, v236
    v_cvt_pk_bf16_f32 v69, v233, v237
    s_waitcnt lgkmcnt(3)
    v_mfma_f32_16x16x32_bf16 v[88:91], v[40:43], a[104:107], v[88:91]
    ds_read_b128 a[120:123], v21 offset:22528
    v_mfma_f32_16x16x32_bf16 v[92:95], v[40:43], a[108:111], v[92:95]
    ds_read_b128 v[40:43], v15 offset:16384
    v_cvt_pk_bf16_f32 v73, v234, v238
    v_cvt_pk_bf16_f32 v77, v235, v239
    s_waitcnt vmcnt(11)
    v_or3_b32 v24, v24, v240, v244
    v_mfma_f32_16x16x32_bf16 v[96:99], v[44:47], a[96:99], v[96:99]
    ds_read_b128 a[124:127], v21 offset:23552
    buffer_load_dwordx4 v[188:191], v8, s[12:15], s63 offen
    v_mfma_f32_16x16x32_bf16 v[100:103], v[44:47], a[100:103], v[100:103]
    v_fma_mix_f32 v240, v240, v30, v34 op_sel_hi:[1,0,0]
    v_fma_mix_f32 v244, v244, v30, v34 op_sel_hi:[1,0,0]
    v_mfma_f32_16x16x32_bf16 v[104:107], v[44:47], a[104:107], v[104:107]
    s_waitcnt vmcnt(10)
    v_or3_b32 v24, v24, v248, v252
    v_mfma_f32_16x16x32_bf16 v[108:111], v[44:47], a[108:111], v[108:111]
    ds_read_b128 v[44:47], v15 offset:20480
    buffer_load_dwordx4 v[192:195], v8, s[12:15], s64 offen
    v_fma_mix_f32 v248, v248, v30, v34 op_sel_hi:[1,0,0]
    v_fma_mix_f32 v252, v252, v30, v34 op_sel_hi:[1,0,0]
    v_cvt_pk_bf16_f32 v66, v240, v244
    s_waitcnt lgkmcnt(4)
    v_mfma_f32_16x16x32_bf16 v[80:83], v[48:51], a[112:115], v[80:83]
    v_cvt_pk_bf16_f32 v67, v248, v252
    v_or3_b32 v25, v25, v241, v245
    v_mfma_f32_16x16x32_bf16 v[84:87], v[48:51], a[116:119], v[84:87]
    s_waitcnt lgkmcnt(1)
    v_mfma_f32_16x16x32_bf16 v[88:91], v[48:51], a[120:123], v[88:91]
    v_mfma_f32_16x16x32_bf16 v[92:95], v[48:51], a[124:127], v[92:95]
    ds_read_b128 v[48:51], v14 offset:24576
    buffer_load_dwordx4 v[196:199], v8, s[12:15], s65 offen
    v_fma_mix_f32 v241, v241, v31, v35 op_sel_hi:[1,0,0]
    v_fma_mix_f32 v245, v245, v31, v35 op_sel_hi:[1,0,0]
    v_mfma_f32_16x16x32_bf16 v[96:99], v[52:55], a[112:115], v[96:99]
    v_or3_b32 v25, v25, v249, v253
    v_fma_mix_f32 v249, v249, v31, v35 op_sel_hi:[1,0,0]
    v_mfma_f32_16x16x32_bf16 v[100:103], v[52:55], a[116:119], v[100:103]
    ds_write_b128 v20, v[64:67] offset:0
    v_fma_mix_f32 v253, v253, v31, v35 op_sel_hi:[1,0,0]
    v_mfma_f32_16x16x32_bf16 v[104:107], v[52:55], a[120:123], v[104:107]
    v_cvt_pk_bf16_f32 v70, v241, v245
    v_cvt_pk_bf16_f32 v71, v249, v253
    v_mfma_f32_16x16x32_bf16 v[108:111], v[52:55], a[124:127], v[108:111]
    buffer_load_dwordx4 v[200:203], v8, s[12:15], s66 offen
    v_or3_b32 v24, v24, v242, v246
    v_mfma_f32_16x16x32_bf16 v[112:115], v[56:59], a[96:99], v[112:115]
    ds_read_b128 v[52:55], v14 offset:28672
    buffer_load_dwordx4 v[204:207], v8, s[12:15], s67 offen
    v_mfma_f32_16x16x32_bf16 v[116:119], v[56:59], a[100:103], v[116:119]
    s_add_u32 m0, s43, 0
    v_fma_mix_f32 v242, v242, v32, v36 op_sel_hi:[1,0,0]
    v_mfma_f32_16x16x32_bf16 v[120:123], v[56:59], a[104:107], v[120:123]
    v_fma_mix_f32 v246, v246, v32, v36 op_sel_hi:[1,0,0]
    v_or3_b32 v24, v24, v250, v254
    v_mfma_f32_16x16x32_bf16 v[124:127], v[56:59], a[108:111], v[124:127]
    ds_write_b128 v20, v[68:71] offset:1024
    v_fma_mix_f32 v250, v250, v32, v36 op_sel_hi:[1,0,0]
    v_mfma_f32_16x16x32_bf16 v[128:131], v[60:63], a[96:99], v[128:131]
    v_fma_mix_f32 v254, v254, v32, v36 op_sel_hi:[1,0,0]
    v_cvt_pk_bf16_f32 v74, v242, v246
    v_mfma_f32_16x16x32_bf16 v[132:135], v[60:63], a[100:103], v[132:135]
    buffer_load_dwordx4 v11, s[8:11], s51 offen lds
    v_cvt_pk_bf16_f32 v75, v250, v254
    v_mfma_f32_16x16x32_bf16 v[136:139], v[60:63], a[104:107], v[136:139]
    v_or3_b32 v25, v25, v243, v247
    ds_read_b128 v[56:59], v15 offset:24576
    v_mfma_f32_16x16x32_bf16 v[140:143], v[60:63], a[108:111], v[140:143]
    ds_read_b128 v[60:63], v15 offset:28672
    v_fma_mix_f32 v243, v243, v33, v37 op_sel_hi:[1,0,0]
    v_fma_mix_f32 v247, v247, v33, v37 op_sel_hi:[1,0,0]
    v_or3_b32 v25, v25, v251, v255
    v_mfma_f32_16x16x32_bf16 v[112:115], v[40:43], a[112:115], v[112:115]
    ds_write_b128 v20, v[72:75] offset:2048
    v_fma_mix_f32 v251, v251, v33, v37 op_sel_hi:[1,0,0]
    v_mfma_f32_16x16x32_bf16 v[116:119], v[40:43], a[116:119], v[116:119]
    v_fma_mix_f32 v255, v255, v33, v37 op_sel_hi:[1,0,0]
    v_cvt_pk_bf16_f32 v78, v243, v247
    v_mfma_f32_16x16x32_bf16 v[120:123], v[40:43], a[120:123], v[120:123]
    buffer_load_dwordx4 v11, s[8:11], s56 offen offset:1024 lds
    s_add_u32 m0, s43, 8192
    v_mfma_f32_16x16x32_bf16 v[124:127], v[40:43], a[124:127], v[124:127]
    v_cvt_pk_bf16_f32 v79, v251, v255
    s_waitcnt vmcnt(8)
    v_or3_b32 v24, v24, v176, v180
    s_waitcnt lgkmcnt(3)
    v_mfma_f32_16x16x32_bf16 v[128:131], v[44:47], a[112:115], v[128:131]
    ds_read_b128 v[40:43], v14 offset:32768
    buffer_load_dwordx4 v11, s[8:11], s52 offen lds
    v_mfma_f32_16x16x32_bf16 v[132:135], v[44:47], a[116:119], v[132:135]
    v_fma_mix_f32 v176, v176, v30, v34 op_sel_hi:[1,0,0]
    v_fma_mix_f32 v180, v180, v30, v34 op_sel_hi:[1,0,0]
    v_or3_b32 v25, v25, v177, v181
    v_fma_mix_f32 v177, v177, v31, v35 op_sel_hi:[1,0,0]
    v_mfma_f32_16x16x32_bf16 v[136:139], v[44:47], a[120:123], v[136:139]
    ds_write_b128 v20, v[76:79] offset:3072
    v_fma_mix_f32 v181, v181, v31, v35 op_sel_hi:[1,0,0]
    v_mfma_f32_16x16x32_bf16 v[140:143], v[44:47], a[124:127], v[140:143]
    v_or3_b32 v24, v24, v178, v182
    v_fma_mix_f32 v178, v178, v32, v36 op_sel_hi:[1,0,0]
    v_mfma_f32_16x16x32_bf16 v[144:147], v[48:51], a[96:99], v[144:147]
    buffer_load_dwordx4 v11, s[8:11], s57 offen offset:1024 lds
    v_fma_mix_f32 v182, v182, v32, v36 op_sel_hi:[1,0,0]
    v_mfma_f32_16x16x32_bf16 v[148:151], v[48:51], a[100:103], v[148:151]
    s_add_u32 m0, s43, 16384
    v_add_u32_e32 v11, s82, v10
    v_or3_b32 v25, v25, v179, v183
    v_mfma_f32_16x16x32_bf16 v[152:155], v[48:51], a[104:107], v[152:155]
    v_fma_mix_f32 v179, v179, v33, v37 op_sel_hi:[1,0,0]
    ds_read_b128 v[44:47], v14 offset:36864
    v_mfma_f32_16x16x32_bf16 v[156:159], v[48:51], a[108:111], v[156:159]
    ds_read_b128 v[48:51], v15 offset:32768
    buffer_load_dwordx4 v11, s[8:11], s50 offen lds
    v_fma_mix_f32 v183, v183, v33, v37 op_sel_hi:[1,0,0]
    v_mfma_f32_16x16x32_bf16 v[160:163], v[52:55], a[96:99], v[160:163]
    v_cvt_pk_bf16_f32 v64, v176, v180
    v_cvt_pk_bf16_f32 v68, v177, v181
    v_mfma_f32_16x16x32_bf16 v[164:167], v[52:55], a[100:103], v[164:167]
    s_waitcnt lgkmcnt(2)
    s_barrier
    v_mfma_f32_16x16x32_bf16 v[168:171], v[52:55], a[104:107], v[168:171]
    ds_read_b128 a[128:131], v21 offset:0
    v_mfma_f32_16x16x32_bf16 v[172:175], v[52:55], a[108:111], v[172:175]
    ds_read_b128 v[52:55], v15 offset:36864
    buffer_load_dwordx4 v11, s[8:11], s55 offen offset:1024 lds
    v_cvt_pk_bf16_f32 v72, v178, v182
    s_mul_i32 s35, s82, 9216
    v_add_u32_e32 v8, s35, v9
    v_mfma_f32_16x16x32_bf16 v[144:147], v[56:59], a[112:115], v[144:147]
    ds_read_b128 a[132:135], v21 offset:1024
    buffer_load_dwordx4 v[208:211], v8, s[12:15], s60 offen
    v_mfma_f32_16x16x32_bf16 v[148:151], v[56:59], a[116:119], v[148:151]
    v_cvt_pk_bf16_f32 v76, v179, v183
    s_waitcnt vmcnt(11)
    v_or3_b32 v24, v24, v184, v188
    v_mfma_f32_16x16x32_bf16 v[152:155], v[56:59], a[120:123], v[152:155]
    v_fma_mix_f32 v184, v184, v30, v34 op_sel_hi:[1,0,0]
    ds_read_b128 a[136:139], v21 offset:2048
    v_mfma_f32_16x16x32_bf16 v[156:159], v[56:59], a[124:127], v[156:159]
    ds_read_b128 v[56:59], v14 offset:40960
    v_fma_mix_f32 v188, v188, v30, v34 op_sel_hi:[1,0,0]
    v_or3_b32 v25, v25, v185, v189
    v_fma_mix_f32 v185, v185, v31, v35 op_sel_hi:[1,0,0]
    v_fma_mix_f32 v189, v189, v31, v35 op_sel_hi:[1,0,0]
    v_mfma_f32_16x16x32_bf16 v[160:163], v[60:63], a[112:115], v[160:163]
    ds_read_b128 a[140:143], v21 offset:3072
    buffer_load_dwordx4 v[212:215], v8, s[12:15], s61 offen
    v_mfma_f32_16x16x32_bf16 v[164:167], v[60:63], a[116:119], v[164:167]
    v_or3_b32 v24, v24, v186, v190
    v_fma_mix_f32 v186, v186, v32, v36 op_sel_hi:[1,0,0]
    v_mfma_f32_16x16x32_bf16 v[168:171], v[60:63], a[120:123], v[168:171]
    v_fma_mix_f32 v190, v190, v32, v36 op_sel_hi:[1,0,0]
    ds_read_b128 a[144:147], v21 offset:4096
    v_mfma_f32_16x16x32_bf16 v[172:175], v[60:63], a[124:127], v[172:175]
    ds_read_b128 v[60:63], v14 offset:45056
    v_or3_b32 v25, v25, v187, v191
    v_fma_mix_f32 v187, v187, v33, v37 op_sel_hi:[1,0,0]
    s_waitcnt lgkmcnt(5)
    v_mfma_f32_16x16x32_bf16 v[80:83], v[40:43], a[128:131], v[80:83]
    ds_read_b128 a[148:151], v21 offset:5120
    buffer_load_dwordx4 v[216:219], v8, s[12:15], s62 offen
    v_mfma_f32_16x16x32_bf16 v[84:87], v[40:43], a[132:135], v[84:87]
    v_fma_mix_f32 v191, v191, v33, v37 op_sel_hi:[1,0,0]
    v_cvt_pk_bf16_f32 v65, v184, v188
    s_waitcnt lgkmcnt(3)
    v_mfma_f32_16x16x32_bf16 v[88:91], v[40:43], a[136:139], v[88:91]
    ds_read_b128 a[152:155], v21 offset:6144
    v_mfma_f32_16x16x32_bf16 v[92:95], v[40:43], a[140:143], v[92:95]
    ds_read_b128 v[40:43], v15 offset:40960
    v_cvt_pk_bf16_f32 v69, v185, v189
    v_cvt_pk_bf16_f32 v73, v186, v190
    v_cvt_pk_bf16_f32 v77, v187, v191
    s_waitcnt vmcnt(11)
    v_mfma_f32_16x16x32_bf16 v[96:99], v[44:47], a[128:131], v[96:99]
    ds_read_b128 a[156:159], v21 offset:7168
    buffer_load_dwordx4 v[220:223], v8, s[12:15], s63 offen
    v_mfma_f32_16x16x32_bf16 v[100:103], v[44:47], a[132:135], v[100:103]
    v_or3_b32 v24, v24, v192, v196
    v_fma_mix_f32 v192, v192, v30, v34 op_sel_hi:[1,0,0]
    v_mfma_f32_16x16x32_bf16 v[104:107], v[44:47], a[136:139], v[104:107]
    v_fma_mix_f32 v196, v196, v30, v34 op_sel_hi:[1,0,0]
    s_waitcnt vmcnt(10)
    v_mfma_f32_16x16x32_bf16 v[108:111], v[44:47], a[140:143], v[108:111]
    ds_read_b128 v[44:47], v15 offset:45056
    buffer_load_dwordx4 v[224:227], v8, s[12:15], s64 offen
    v_or3_b32 v24, v24, v200, v204
    v_fma_mix_f32 v200, v200, v30, v34 op_sel_hi:[1,0,0]
    v_fma_mix_f32 v204, v204, v30, v34 op_sel_hi:[1,0,0]
    s_waitcnt lgkmcnt(4)
    v_mfma_f32_16x16x32_bf16 v[80:83], v[48:51], a[144:147], v[80:83]
    v_cvt_pk_bf16_f32 v66, v192, v196
    v_cvt_pk_bf16_f32 v67, v200, v204
    v_mfma_f32_16x16x32_bf16 v[84:87], v[48:51], a[148:151], v[84:87]
    s_waitcnt lgkmcnt(1)
    v_mfma_f32_16x16x32_bf16 v[88:91], v[48:51], a[152:155], v[88:91]
L_tL1:
    s_cbranch_execz L_retL
    v_mfma_f32_16x16x32_bf16 v[92:95], v[48:51], a[156:159], v[92:95]
    ds_read_b128 v[48:51], v14 offset:49152
    buffer_load_dwordx4 v[228:231], v8, s[12:15], s65 offen
    v_or3_b32 v25, v25, v193, v197
    v_fma_mix_f32 v193, v193, v31, v35 op_sel_hi:[1,0,0]
    v_fma_mix_f32 v197, v197, v31, v35 op_sel_hi:[1,0,0]
    v_or3_b32 v25, v25, v201, v205
    v_mfma_f32_16x16x32_bf16 v[96:99], v[52:55], a[144:147], v[96:99]
    ds_write_b128 v20, v[64:67] offset:16384
    v_mfma_f32_16x16x32_bf16 v[100:103], v[52:55], a[148:151], v[100:103]
    v_fma_mix_f32 v201, v201, v31, v35 op_sel_hi:[1,0,0]
    v_fma_mix_f32 v205, v205, v31, v35 op_sel_hi:[1,0,0]
    v_mfma_f32_16x16x32_bf16 v[104:107], v[52:55], a[152:155], v[104:107]
    v_cvt_pk_bf16_f32 v70, v193, v197
    buffer_load_dwordx4 v[232:235], v8, s[12:15], s66 offen
    v_mfma_f32_16x16x32_bf16 v[108:111], v[52:55], a[156:159], v[108:111]
    v_cvt_pk_bf16_f32 v71, v201, v205
    v_or3_b32 v24, v24, v194, v198
    v_mfma_f32_16x16x32_bf16 v[112:115], v[56:59], a[128:131], v[112:115]
    ds_read_b128 v[52:55], v14 offset:53248
    buffer_load_dwordx4 v[236:239], v8, s[12:15], s67 offen
    v_mfma_f32_16x16x32_bf16 v[116:119], v[56:59], a[132:135], v[116:119]
    s_add_u32 m0, s43, 24576
    v_fma_mix_f32 v194, v194, v32, v36 op_sel_hi:[1,0,0]
    v_mfma_f32_16x16x32_bf16 v[120:123], v[56:59], a[136:139], v[120:123]
    v_fma_mix_f32 v198, v198, v32, v36 op_sel_hi:[1,0,0]
    v_or3_b32 v24, v24, v202, v206
    v_mfma_f32_16x16x32_bf16 v[124:127], v[56:59], a[140:143], v[124:127]
    ds_write_b128 v20, v[68:71] offset:17408
    v_fma_mix_f32 v202, v202, v32, v36 op_sel_hi:[1,0,0]
    v_mfma_f32_16x16x32_bf16 v[128:131], v[60:63], a[128:131], v[128:131]
    v_fma_mix_f32 v206, v206, v32, v36 op_sel_hi:[1,0,0]
    v_cvt_pk_bf16_f32 v74, v194, v198
    v_mfma_f32_16x16x32_bf16 v[132:135], v[60:63], a[132:135], v[132:135]
    buffer_load_dwordx4 v11, s[8:11], s51 offen lds
    v_cvt_pk_bf16_f32 v75, v202, v206
    v_mfma_f32_16x16x32_bf16 v[136:139], v[60:63], a[136:139], v[136:139]
    v_or3_b32 v25, v25, v195, v199
    ds_read_b128 v[56:59], v15 offset:49152
    v_mfma_f32_16x16x32_bf16 v[140:143], v[60:63], a[140:143], v[140:143]
    ds_read_b128 v[60:63], v15 offset:53248
    v_fma_mix_f32 v195, v195, v33, v37 op_sel_hi:[1,0,0]
    v_fma_mix_f32 v199, v199, v33, v37 op_sel_hi:[1,0,0]
    v_or3_b32 v25, v25, v203, v207
    v_fma_mix_f32 v203, v203, v33, v37 op_sel_hi:[1,0,0]
    v_mfma_f32_16x16x32_bf16 v[112:115], v[40:43], a[144:147], v[112:115]
    ds_write_b128 v20, v[72:75] offset:18432
    v_fma_mix_f32 v207, v207, v33, v37 op_sel_hi:[1,0,0]
    v_mfma_f32_16x16x32_bf16 v[116:119], v[40:43], a[148:151], v[116:119]
    v_cvt_pk_bf16_f32 v78, v195, v199
    v_cvt_pk_bf16_f32 v79, v203, v207
    v_mfma_f32_16x16x32_bf16 v[120:123], v[40:43], a[152:155], v[120:123]
    buffer_load_dwordx4 v11, s[8:11], s56 offen offset:1024 lds
    s_add_u32 m0, s43, 32768
    v_mfma_f32_16x16x32_bf16 v[124:127], v[40:43], a[156:159], v[124:127]
    s_waitcnt vmcnt(8)
    v_or3_b32 v24, v24, v208, v212
    v_fma_mix_f32 v208, v208, v30, v34 op_sel_hi:[1,0,0]
    s_waitcnt lgkmcnt(3)
    v_mfma_f32_16x16x32_bf16 v[128:131], v[44:47], a[144:147], v[128:131]
    ds_read_b128 v[40:43], v14 offset:57344
    buffer_load_dwordx4 v11, s[8:11], s52 offen lds
    v_mfma_f32_16x16x32_bf16 v[132:135], v[44:47], a[148:151], v[132:135]
    v_fma_mix_f32 v212, v212, v30, v34 op_sel_hi:[1,0,0]
    v_or3_b32 v25, v25, v209, v213
    v_fma_mix_f32 v209, v209, v31, v35 op_sel_hi:[1,0,0]
    v_fma_mix_f32 v213, v213, v31, v35 op_sel_hi:[1,0,0]
    v_mfma_f32_16x16x32_bf16 v[136:139], v[44:47], a[152:155], v[136:139]
    ds_write_b128 v20, v[76:79] offset:19456
    v_or3_b32 v24, v24, v210, v214
    v_mfma_f32_16x16x32_bf16 v[140:143], v[44:47], a[156:159], v[140:143]
    v_fma_mix_f32 v210, v210, v32, v36 op_sel_hi:[1,0,0]
    v_fma_mix_f32 v214, v214, v32, v36 op_sel_hi:[1,0,0]
    v_mfma_f32_16x16x32_bf16 v[144:147], v[48:51], a[128:131], v[144:147]
    buffer_load_dwordx4 v11, s[8:11], s57 offen offset:1024 lds
    s_add_u32 m0, s43, 40960
    v_mfma_f32_16x16x32_bf16 v[148:151], v[48:51], a[132:135], v[148:151]
    v_add_u32_e32 v11, s83, v10
    v_or3_b32 v25, v25, v211, v215
    v_fma_mix_f32 v211, v211, v33, v37 op_sel_hi:[1,0,0]
    v_mfma_f32_16x16x32_bf16 v[152:155], v[48:51], a[136:139], v[152:155]
    v_fma_mix_f32 v215, v215, v33, v37 op_sel_hi:[1,0,0]
    ds_read_b128 v[44:47], v14 offset:61440
    v_mfma_f32_16x16x32_bf16 v[156:159], v[48:51], a[140:143], v[156:159]
    ds_read_b128 v[48:51], v15 offset:57344
    buffer_load_dwordx4 v11, s[8:11], s50 offen lds
    v_mfma_f32_16x16x32_bf16 v[160:163], v[52:55], a[128:131], v[160:163]
    v_cvt_pk_bf16_f32 v64, v208, v212
    v_cvt_pk_bf16_f32 v68, v209, v213
    v_mfma_f32_16x16x32_bf16 v[164:167], v[52:55], a[132:135], v[164:167]
    s_waitcnt lgkmcnt(2)
    s_barrier
    v_mfma_f32_16x16x32_bf16 v[168:171], v[52:55], a[136:139], v[168:171]
    ds_read_b128 a[160:163], v21 offset:16384
    v_mfma_f32_16x16x32_bf16 v[172:175], v[52:55], a[140:143], v[172:175]
    ds_read_b128 v[52:55], v15 offset:61440
    buffer_load_dwordx4 v11, s[8:11], s55 offen offset:1024 lds
    s_mul_i32 s35, s83, 9216
    v_add_u32_e32 v8, s35, v9
    v_cvt_pk_bf16_f32 v72, v210, v214
    v_mfma_f32_16x16x32_bf16 v[144:147], v[56:59], a[144:147], v[144:147]
    ds_read_b128 a[164:167], v21 offset:17408
    buffer_load_dwordx4 v[240:243], v8, s[12:15], s60 offen
    v_mfma_f32_16x16x32_bf16 v[148:151], v[56:59], a[148:151], v[148:151]
    v_cvt_pk_bf16_f32 v76, v211, v215
    s_waitcnt vmcnt(11)
    v_or3_b32 v24, v24, v216, v220
    v_mfma_f32_16x16x32_bf16 v[152:155], v[56:59], a[152:155], v[152:155]
    v_fma_mix_f32 v216, v216, v30, v34 op_sel_hi:[1,0,0]
    ds_read_b128 a[168:171], v21 offset:18432
    v_mfma_f32_16x16x32_bf16 v[156:159], v[56:59], a[156:159], v[156:159]
    ds_read_b128 v[56:59], v12 offset:0
    v_fma_mix_f32 v220, v220, v30, v34 op_sel_hi:[1,0,0]
    v_or3_b32 v25, v25, v217, v221
    v_fma_mix_f32 v217, v217, v31, v35 op_sel_hi:[1,0,0]
    v_fma_mix_f32 v221, v221, v31, v35 op_sel_hi:[1,0,0]
    v_mfma_f32_16x16x32_bf16 v[160:163], v[60:63], a[144:147], v[160:163]
    ds_read_b128 a[172:175], v21 offset:19456
    buffer_load_dwordx4 v[244:247], v8, s[12:15], s61 offen
    v_mfma_f32_16x16x32_bf16 v[164:167], v[60:63], a[148:151], v[164:167]
    v_or3_b32 v24, v24, v218, v222
    v_fma_mix_f32 v218, v218, v32, v36 op_sel_hi:[1,0,0]
    v_mfma_f32_16x16x32_bf16 v[168:171], v[60:63], a[152:155], v[168:171]
    v_fma_mix_f32 v222, v222, v32, v36 op_sel_hi:[1,0,0]
    ds_read_b128 a[176:179], v21 offset:20480
    v_mfma_f32_16x16x32_bf16 v[172:175], v[60:63], a[156:159], v[172:175]
    ds_read_b128 v[60:63], v12 offset:4096
    v_or3_b32 v25, v25, v219, v223
    v_fma_mix_f32 v219, v219, v33, v37 op_sel_hi:[1,0,0]
    s_waitcnt lgkmcnt(5)
    v_mfma_f32_16x16x32_bf16 v[80:83], v[40:43], a[160:163], v[80:83]
    ds_read_b128 a[180:183], v21 offset:21504
    buffer_load_dwordx4 v[248:251], v8, s[12:15], s62 offen
    v_mfma_f32_16x16x32_bf16 v[84:87], v[40:43], a[164:167], v[84:87]
    v_fma_mix_f32 v223, v223, v33, v37 op_sel_hi:[1,0,0]
    v_cvt_pk_bf16_f32 v65, v216, v220
    s_waitcnt lgkmcnt(3)
    v_mfma_f32_16x16x32_bf16 v[88:91], v[40:43], a[168:171], v[88:91]
    ds_read_b128 a[184:187], v21 offset:22528
    v_mfma_f32_16x16x32_bf16 v[92:95], v[40:43], a[172:175], v[92:95]
    ds_read_b128 v[40:43], v13 offset:0
    v_cvt_pk_bf16_f32 v69, v217, v221
    v_cvt_pk_bf16_f32 v73, v218, v222
    v_cvt_pk_bf16_f32 v77, v219, v223
    s_waitcnt vmcnt(11)
    v_mfma_f32_16x16x32_bf16 v[96:99], v[44:47], a[160:163], v[96:99]
    ds_read_b128 a[188:191], v21 offset:23552
    buffer_load_dwordx4 v[252:255], v8, s[12:15], s63 offen
    v_mfma_f32_16x16x32_bf16 v[100:103], v[44:47], a[164:167], v[100:103]
    v_or3_b32 v24, v24, v224, v228
    v_fma_mix_f32 v224, v224, v30, v34 op_sel_hi:[1,0,0]
    v_mfma_f32_16x16x32_bf16 v[104:107], v[44:47], a[168:171], v[104:107]
    v_fma_mix_f32 v228, v228, v30, v34 op_sel_hi:[1,0,0]
    s_waitcnt vmcnt(10)
    v_mfma_f32_16x16x32_bf16 v[108:111], v[44:47], a[172:175], v[108:111]
    ds_read_b128 v[44:47], v13 offset:4096
    buffer_load_dwordx4 v[176:179], v8, s[12:15], s64 offen
    v_or3_b32 v24, v24, v232, v236
    v_fma_mix_f32 v232, v232, v30, v34 op_sel_hi:[1,0,0]
    v_fma_mix_f32 v236, v236, v30, v34 op_sel_hi:[1,0,0]
    s_waitcnt lgkmcnt(4)
    v_mfma_f32_16x16x32_bf16 v[80:83], v[48:51], a[176:179], v[80:83]
    v_cvt_pk_bf16_f32 v66, v224, v228
    v_cvt_pk_bf16_f32 v67, v232, v236
    v_mfma_f32_16x16x32_bf16 v[84:87], v[48:51], a[180:183], v[84:87]
    v_or3_b32 v25, v25, v225, v229
    s_waitcnt lgkmcnt(1)
    v_mfma_f32_16x16x32_bf16 v[88:91], v[48:51], a[184:187], v[88:91]
    v_mfma_f32_16x16x32_bf16 v[92:95], v[48:51], a[188:191], v[92:95]
    ds_read_b128 v[48:51], v12 offset:8192
    buffer_load_dwordx4 v[180:183], v8, s[12:15], s65 offen
    v_fma_mix_f32 v225, v225, v31, v35 op_sel_hi:[1,0,0]
    v_fma_mix_f32 v229, v229, v31, v35 op_sel_hi:[1,0,0]
    v_or3_b32 v25, v25, v233, v237
    v_mfma_f32_16x16x32_bf16 v[96:99], v[52:55], a[176:179], v[96:99]
    ds_write_b128 v20, v[64:67] offset:0
    v_mfma_f32_16x16x32_bf16 v[100:103], v[52:55], a[180:183], v[100:103]
    v_fma_mix_f32 v233, v233, v31, v35 op_sel_hi:[1,0,0]
    v_fma_mix_f32 v237, v237, v31, v35 op_sel_hi:[1,0,0]
    v_mfma_f32_16x16x32_bf16 v[104:107], v[52:55], a[184:187], v[104:107]
    v_cvt_pk_bf16_f32 v70, v225, v229
    buffer_load_dwordx4 v[184:187], v8, s[12:15], s66 offen
    v_mfma_f32_16x16x32_bf16 v[108:111], v[52:55], a[188:191], v[108:111]
    v_cvt_pk_bf16_f32 v71, v233, v237
    v_or3_b32 v24, v24, v226, v230
    v_mfma_f32_16x16x32_bf16 v[112:115], v[56:59], a[160:163], v[112:115]
    ds_read_b128 v[52:55], v12 offset:12288
    buffer_load_dwordx4 v[188:191], v8, s[12:15], s67 offen
    v_mfma_f32_16x16x32_bf16 v[116:119], v[56:59], a[164:167], v[116:119]
    s_add_u32 m0, s43, 49152
    v_fma_mix_f32 v226, v226, v32, v36 op_sel_hi:[1,0,0]
    v_mfma_f32_16x16x32_bf16 v[120:123], v[56:59], a[168:171], v[120:123]
    v_fma_mix_f32 v230, v230, v32, v36 op_sel_hi:[1,0,0]
    v_or3_b32 v24, v24, v234, v238
    v_mfma_f32_16x16x32_bf16 v[124:127], v[56:59], a[172:175], v[124:127]
    ds_write_b128 v20, v[68:71] offset:1024
    v_mfma_f32_16x16x32_bf16 v[128:131], v[60:63], a[160:163], v[128:131]
    v_fma_mix_f32 v234, v234, v32, v36 op_sel_hi:[1,0,0]
    v_fma_mix_f32 v238, v238, v32, v36 op_sel_hi:[1,0,0]
    v_mfma_f32_16x16x32_bf16 v[132:135], v[60:63], a[164:167], v[132:135]
    v_cvt_pk_bf16_f32 v74, v226, v230
    buffer_load_dwordx4 v11, s[8:11], s51 offen lds
    v_mfma_f32_16x16x32_bf16 v[136:139], v[60:63], a[168:171], v[136:139]
    v_cvt_pk_bf16_f32 v75, v234, v238
    ds_read_b128 v[56:59], v13 offset:8192
    v_mfma_f32_16x16x32_bf16 v[140:143], v[60:63], a[172:175], v[140:143]
    ds_read_b128 v[60:63], v13 offset:12288
    v_or3_b32 v25, v25, v227, v231
    v_fma_mix_f32 v227, v227, v33, v37 op_sel_hi:[1,0,0]
    v_fma_mix_f32 v231, v231, v33, v37 op_sel_hi:[1,0,0]
    v_or3_b32 v25, v25, v235, v239
    v_mfma_f32_16x16x32_bf16 v[112:115], v[40:43], a[176:179], v[112:115]
    ds_write_b128 v20, v[72:75] offset:2048
    v_fma_mix_f32 v235, v235, v33, v37 op_sel_hi:[1,0,0]
    v_mfma_f32_16x16x32_bf16 v[116:119], v[40:43], a[180:183], v[116:119]
    v_fma_mix_f32 v239, v239, v33, v37 op_sel_hi:[1,0,0]
    v_cvt_pk_bf16_f32 v78, v227, v231
    v_mfma_f32_16x16x32_bf16 v[120:123], v[40:43], a[184:187], v[120:123]
    buffer_load_dwordx4 v11, s[8:11], s56 offen offset:1024 lds
    s_add_u32 m0, s43, 57344
    v_mfma_f32_16x16x32_bf16 v[124:127], v[40:43], a[188:191], v[124:127]
    v_cvt_pk_bf16_f32 v79, v235, v239
    s_waitcnt vmcnt(8)
    v_or3_b32 v24, v24, v240, v244
    s_waitcnt lgkmcnt(3)
    v_mfma_f32_16x16x32_bf16 v[128:131], v[44:47], a[176:179], v[128:131]
    ds_read_b128 v[40:43], v12 offset:16384
    buffer_load_dwordx4 v11, s[8:11], s52 offen lds
    v_mfma_f32_16x16x32_bf16 v[132:135], v[44:47], a[180:183], v[132:135]
    v_fma_mix_f32 v240, v240, v30, v34 op_sel_hi:[1,0,0]
    v_fma_mix_f32 v244, v244, v30, v34 op_sel_hi:[1,0,0]
    v_or3_b32 v25, v25, v241, v245
    v_fma_mix_f32 v241, v241, v31, v35 op_sel_hi:[1,0,0]
    v_mfma_f32_16x16x32_bf16 v[136:139], v[44:47], a[184:187], v[136:139]
    ds_write_b128 v20, v[76:79] offset:3072
    v_fma_mix_f32 v245, v245, v31, v35 op_sel_hi:[1,0,0]
    v_mfma_f32_16x16x32_bf16 v[140:143], v[44:47], a[188:191], v[140:143]
    v_or3_b32 v24, v24, v242, v246
    v_fma_mix_f32 v242, v242, v32, v36 op_sel_hi:[1,0,0]
    v_mfma_f32_16x16x32_bf16 v[144:147], v[48:51], a[160:163], v[144:147]
    buffer_load_dwordx4 v11, s[8:11], s57 offen offset:1024 lds
    v_fma_mix_f32 v246, v246, v32, v36 op_sel_hi:[1,0,0]
    v_mfma_f32_16x16x32_bf16 v[148:151], v[48:51], a[164:167], v[148:151]
    s_add_u32 m0, s43, 65536
    v_add_u32_e32 v11, s84, v10
    v_or3_b32 v25, v25, v243, v247
    v_mfma_f32_16x16x32_bf16 v[152:155], v[48:51], a[168:171], v[152:155]
    v_fma_mix_f32 v243, v243, v33, v37 op_sel_hi:[1,0,0]
    ds_read_b128 v[44:47], v12 offset:20480
    v_mfma_f32_16x16x32_bf16 v[156:159], v[48:51], a[172:175], v[156:159]
    ds_read_b128 v[48:51], v13 offset:16384
    buffer_load_dwordx4 v11, s[8:11], s50 offen lds
    v_fma_mix_f32 v247, v247, v33, v37 op_sel_hi:[1,0,0]
    v_mfma_f32_16x16x32_bf16 v[160:163], v[52:55], a[160:163], v[160:163]
    v_cvt_pk_bf16_f32 v64, v240, v244
    v_cvt_pk_bf16_f32 v68, v241, v245
    v_mfma_f32_16x16x32_bf16 v[164:167], v[52:55], a[164:167], v[164:167]
    s_waitcnt lgkmcnt(2)
    s_barrier
    v_mfma_f32_16x16x32_bf16 v[168:171], v[52:55], a[168:171], v[168:171]
    ds_read_b128 a[192:195], v21 offset:0
    v_mfma_f32_16x16x32_bf16 v[172:175], v[52:55], a[172:175], v[172:175]
    ds_read_b128 v[52:55], v13 offset:20480
    buffer_load_dwordx4 v11, s[8:11], s55 offen offset:1024 lds
    v_cvt_pk_bf16_f32 v72, v242, v246
    s_mul_i32 s35, s84, 9216
    v_add_u32_e32 v8, s35, v9
    v_mfma_f32_16x16x32_bf16 v[144:147], v[56:59], a[176:179], v[144:147]
    ds_read_b128 a[196:199], v21 offset:1024
    buffer_load_dwordx4 v[192:195], v8, s[12:15], s60 offen
    v_mfma_f32_16x16x32_bf16 v[148:151], v[56:59], a[180:183], v[148:151]
    v_cvt_pk_bf16_f32 v76, v243, v247
    s_waitcnt vmcnt(11)
    v_or3_b32 v24, v24, v248, v252
    v_mfma_f32_16x16x32_bf16 v[152:155], v[56:59], a[184:187], v[152:155]
    v_fma_mix_f32 v248, v248, v30, v34 op_sel_hi:[1,0,0]
    ds_read_b128 a[200:203], v21 offset:2048
    v_mfma_f32_16x16x32_bf16 v[156:159], v[56:59], a[188:191], v[156:159]
    ds_read_b128 v[56:59], v12 offset:24576
    v_fma_mix_f32 v252, v252, v30, v34 op_sel_hi:[1,0,0]
    v_or3_b32 v25, v25, v249, v253
    v_fma_mix_f32 v249, v249, v31, v35 op_sel_hi:[1,0,0]
    v_fma_mix_f32 v253, v253, v31, v35 op_sel_hi:[1,0,0]
    v_mfma_f32_16x16x32_bf16 v[160:163], v[60:63], a[176:179], v[160:163]
    ds_read_b128 a[204:207], v21 offset:3072
    buffer_load_dwordx4 v[196:199], v8, s[12:15], s61 offen
    v_mfma_f32_16x16x32_bf16 v[164:167], v[60:63], a[180:183], v[164:167]
    v_or3_b32 v24, v24, v250, v254
    v_fma_mix_f32 v250, v250, v32, v36 op_sel_hi:[1,0,0]
    v_mfma_f32_16x16x32_bf16 v[168:171], v[60:63], a[184:187], v[168:171]
    v_fma_mix_f32 v254, v254, v32, v36 op_sel_hi:[1,0,0]
    ds_read_b128 a[208:211], v21 offset:4096
    v_mfma_f32_16x16x32_bf16 v[172:175], v[60:63], a[188:191], v[172:175]
    ds_read_b128 v[60:63], v12 offset:28672
    v_or3_b32 v25, v25, v251, v255
    v_fma_mix_f32 v251, v251, v33, v37 op_sel_hi:[1,0,0]
    s_waitcnt lgkmcnt(5)
    v_mfma_f32_16x16x32_bf16 v[80:83], v[40:43], a[192:195], v[80:83]
    ds_read_b128 a[212:215], v21 offset:5120
    buffer_load_dwordx4 v[200:203], v8, s[12:15], s62 offen
    v_mfma_f32_16x16x32_bf16 v[84:87], v[40:43], a[196:199], v[84:87]
    v_fma_mix_f32 v255, v255, v33, v37 op_sel_hi:[1,0,0]
    v_cvt_pk_bf16_f32 v65, v248, v252
    s_waitcnt lgkmcnt(3)
    v_mfma_f32_16x16x32_bf16 v[88:91], v[40:43], a[200:203], v[88:91]
    ds_read_b128 a[216:219], v21 offset:6144
    v_mfma_f32_16x16x32_bf16 v[92:95], v[40:43], a[204:207], v[92:95]
    ds_read_b128 v[40:43], v13 offset:24576
    v_cvt_pk_bf16_f32 v69, v249, v253
    v_cvt_pk_bf16_f32 v73, v250, v254
    v_cvt_pk_bf16_f32 v77, v251, v255
    v_mfma_f32_16x16x32_bf16 v[96:99], v[44:47], a[192:195], v[96:99]
    ds_read_b128 a[220:223], v21 offset:7168
    buffer_load_dwordx4 v[204:207], v8, s[12:15], s63 offen
    v_mfma_f32_16x16x32_bf16 v[100:103], v[44:47], a[196:199], v[100:103]
    s_waitcnt vmcnt(12)
    v_or3_b32 v24, v24, v176, v180
    v_mfma_f32_16x16x32_bf16 v[104:107], v[44:47], a[200:203], v[104:107]
    v_fma_mix_f32 v176, v176, v30, v34 op_sel_hi:[1,0,0]
    v_fma_mix_f32 v180, v180, v30, v34 op_sel_hi:[1,0,0]
    v_mfma_f32_16x16x32_bf16 v[108:111], v[44:47], a[204:207], v[108:111]
    ds_read_b128 v[44:47], v13 offset:28672
    buffer_load_dwordx4 v[208:211], v8, s[12:15], s64 offen
    s_waitcnt vmcnt(11)
    v_or3_b32 v24, v24, v184, v188
    v_fma_mix_f32 v184, v184, v30, v34 op_sel_hi:[1,0,0]
    s_waitcnt lgkmcnt(4)
    v_mfma_f32_16x16x32_bf16 v[80:83], v[48:51], a[208:211], v[80:83]
    v_fma_mix_f32 v188, v188, v30, v34 op_sel_hi:[1,0,0]
    v_cvt_pk_bf16_f32 v66, v176, v180
    v_mfma_f32_16x16x32_bf16 v[84:87], v[48:51], a[212:215], v[84:87]
    v_cvt_pk_bf16_f32 v67, v184, v188
    v_or3_b32 v25, v25, v177, v181
    s_waitcnt lgkmcnt(1)
    v_mfma_f32_16x16x32_bf16 v[88:91], v[48:51], a[216:219], v[88:91]
    v_mfma_f32_16x16x32_bf16 v[92:95], v[48:51], a[220:223], v[92:95]
    ds_read_b128 v[48:51], v12 offset:32768
    buffer_load_dwordx4 v[212:215], v8, s[12:15], s65 offen
    v_fma_mix_f32 v177, v177, v31, v35 op_sel_hi:[1,0,0]
    v_fma_mix_f32 v181, v181, v31, v35 op_sel_hi:[1,0,0]
    v_mfma_f32_16x16x32_bf16 v[96:99], v[52:55], a[208:211], v[96:99]
    v_or3_b32 v25, v25, v185, v189
    v_fma_mix_f32 v185, v185, v31, v35 op_sel_hi:[1,0,0]
    v_mfma_f32_16x16x32_bf16 v[100:103], v[52:55], a[212:215], v[100:103]
    ds_write_b128 v20, v[64:67] offset:16384
    v_fma_mix_f32 v189, v189, v31, v35 op_sel_hi:[1,0,0]
    v_mfma_f32_16x16x32_bf16 v[104:107], v[52:55], a[216:219], v[104:107]
    v_cvt_pk_bf16_f32 v70, v177, v181
    v_cvt_pk_bf16_f32 v71, v185, v189
    v_mfma_f32_16x16x32_bf16 v[108:111], v[52:55], a[220:223], v[108:111]
    buffer_load_dwordx4 v[216:219], v8, s[12:15], s66 offen
    v_or3_b32 v24, v24, v178, v182
    v_mfma_f32_16x16x32_bf16 v[112:115], v[56:59], a[192:195], v[112:115]
    ds_read_b128 v[52:55], v12 offset:36864
    buffer_load_dwordx4 v[220:223], v8, s[12:15], s67 offen
    v_mfma_f32_16x16x32_bf16 v[116:119], v[56:59], a[196:199], v[116:119]
    s_add_u32 m0, s43, 73728
    v_fma_mix_f32 v178, v178, v32, v36 op_sel_hi:[1,0,0]
    v_mfma_f32_16x16x32_bf16 v[120:123], v[56:59], a[200:203], v[120:123]
    v_fma_mix_f32 v182, v182, v32, v36 op_sel_hi:[1,0,0]
    v_or3_b32 v24, v24, v186, v190
    v_mfma_f32_16x16x32_bf16 v[124:127], v[56:59], a[204:207], v[124:127]
    ds_write_b128 v20, v[68:71] offset:17408
    v_fma_mix_f32 v186, v186, v32, v36 op_sel_hi:[1,0,0]
    v_mfma_f32_16x16x32_bf16 v[128:131], v[60:63], a[192:195], v[128:131]
    v_fma_mix_f32 v190, v190, v32, v36 op_sel_hi:[1,0,0]
    v_cvt_pk_bf16_f32 v74, v178, v182
    v_mfma_f32_16x16x32_bf16 v[132:135], v[60:63], a[196:199], v[132:135]
    buffer_load_dwordx4 v11, s[8:11], s51 offen lds
    v_cvt_pk_bf16_f32 v75, v186, v190
    v_mfma_f32_16x16x32_bf16 v[136:139], v[60:63], a[200:203], v[136:139]
    v_or3_b32 v25, v25, v179, v183
    ds_read_b128 v[56:59], v13 offset:32768
    v_mfma_f32_16x16x32_bf16 v[140:143], v[60:63], a[204:207], v[140:143]
    ds_read_b128 v[60:63], v13 offset:36864
    v_fma_mix_f32 v179, v179, v33, v37 op_sel_hi:[1,0,0]
    v_fma_mix_f32 v183, v183, v33, v37 op_sel_hi:[1,0,0]
    v_or3_b32 v25, v25, v187, v191
    v_mfma_f32_16x16x32_bf16 v[112:115], v[40:43], a[208:211], v[112:115]
    ds_write_b128 v20, v[72:75] offset:18432
    v_fma_mix_f32 v187, v187, v33, v37 op_sel_hi:[1,0,0]
    v_mfma_f32_16x16x32_bf16 v[116:119], v[40:43], a[212:215], v[116:119]
    v_fma_mix_f32 v191, v191, v33, v37 op_sel_hi:[1,0,0]
    v_cvt_pk_bf16_f32 v78, v179, v183
    v_mfma_f32_16x16x32_bf16 v[120:123], v[40:43], a[216:219], v[120:123]
    buffer_load_dwordx4 v11, s[8:11], s56 offen offset:1024 lds
    s_add_u32 m0, s43, 81920
    v_mfma_f32_16x16x32_bf16 v[124:127], v[40:43], a[220:223], v[124:127]
    v_cvt_pk_bf16_f32 v79, v187, v191
    s_waitcnt vmcnt(8)
    v_or3_b32 v24, v24, v192, v196
    s_waitcnt lgkmcnt(3)
    v_mfma_f32_16x16x32_bf16 v[128:131], v[44:47], a[208:211], v[128:131]
    ds_read_b128 v[40:43], v12 offset:40960
    buffer_load_dwordx4 v11, s[8:11], s52 offen lds
    v_mfma_f32_16x16x32_bf16 v[132:135], v[44:47], a[212:215], v[132:135]
    v_fma_mix_f32 v192, v192, v30, v34 op_sel_hi:[1,0,0]
    v_fma_mix_f32 v196, v196, v30, v34 op_sel_hi:[1,0,0]
    v_or3_b32 v25, v25, v193, v197
    v_fma_mix_f32 v193, v193, v31, v35 op_sel_hi:[1,0,0]
    v_mfma_f32_16x16x32_bf16 v[136:139], v[44:47], a[216:219], v[136:139]
    ds_write_b128 v20, v[76:79] offset:19456
    v_fma_mix_f32 v197, v197, v31, v35 op_sel_hi:[1,0,0]
    v_mfma_f32_16x16x32_bf16 v[140:143], v[44:47], a[220:223], v[140:143]
    v_or3_b32 v24, v24, v194, v198
    v_fma_mix_f32 v194, v194, v32, v36 op_sel_hi:[1,0,0]
    v_mfma_f32_16x16x32_bf16 v[144:147], v[48:51], a[192:195], v[144:147]
    buffer_load_dwordx4 v11, s[8:11], s57 offen offset:1024 lds
    s_add_u32 m0, s43, 90112
    v_mfma_f32_16x16x32_bf16 v[148:151], v[48:51], a[196:199], v[148:151]
    v_add_u32_e32 v11, s76, v10
    v_fma_mix_f32 v198, v198, v32, v36 op_sel_hi:[1,0,0]
    v_or3_b32 v25, v25, v195, v199
    v_mfma_f32_16x16x32_bf16 v[152:155], v[48:51], a[200:203], v[152:155]
    v_fma_mix_f32 v195, v195, v33, v37 op_sel_hi:[1,0,0]
    ds_read_b128 v[44:47], v12 offset:45056
    v_mfma_f32_16x16x32_bf16 v[156:159], v[48:51], a[204:207], v[156:159]
    ds_read_b128 v[48:51], v13 offset:40960
    v_fma_mix_f32 v199, v199, v33, v37 op_sel_hi:[1,0,0]
    v_mfma_f32_16x16x32_bf16 v[160:163], v[52:55], a[192:195], v[160:163]
    v_cvt_pk_bf16_f32 v64, v192, v196
    v_cvt_pk_bf16_f32 v68, v193, v197
    v_mfma_f32_16x16x32_bf16 v[164:167], v[52:55], a[196:199], v[164:167]
    s_waitcnt lgkmcnt(2)
    s_barrier
    v_mfma_f32_16x16x32_bf16 v[168:171], v[52:55], a[200:203], v[168:171]
    ds_read_b128 a[224:227], v21 offset:16384
    v_mfma_f32_16x16x32_bf16 v[172:175], v[52:55], a[204:207], v[172:175]
    ds_read_b128 v[52:55], v13 offset:45056
    buffer_load_dwordx4 v11, s[8:11], s53 offen lds
    v_cvt_pk_bf16_f32 v72, v194, v198
    v_cvt_pk_bf16_f32 v76, v195, v199
    s_waitcnt vmcnt(9)
    v_mfma_f32_16x16x32_bf16 v[144:147], v[56:59], a[208:211], v[144:147]
    ds_read_b128 a[228:231], v21 offset:17408
    buffer_load_dwordx4 v11, s[8:11], s58 offen offset:1024 lds
    v_mfma_f32_16x16x32_bf16 v[148:151], v[56:59], a[212:215], v[148:151]
    s_add_u32 m0, s43, 98304
    v_add_u32_e32 v11, s77, v10
    v_or3_b32 v24, v24, v200, v204
    v_mfma_f32_16x16x32_bf16 v[152:155], v[56:59], a[216:219], v[152:155]
    v_fma_mix_f32 v200, v200, v30, v34 op_sel_hi:[1,0,0]
    ds_read_b128 a[232:235], v21 offset:18432
    v_mfma_f32_16x16x32_bf16 v[156:159], v[56:59], a[220:223], v[156:159]
    ds_read_b128 v[56:59], v12 offset:49152
    v_fma_mix_f32 v204, v204, v30, v34 op_sel_hi:[1,0,0]
    v_or3_b32 v25, v25, v201, v205
    v_fma_mix_f32 v201, v201, v31, v35 op_sel_hi:[1,0,0]
    v_mfma_f32_16x16x32_bf16 v[160:163], v[60:63], a[208:211], v[160:163]
    v_fma_mix_f32 v205, v205, v31, v35 op_sel_hi:[1,0,0]
    ds_read_b128 a[236:239], v21 offset:19456
    v_mfma_f32_16x16x32_bf16 v[164:167], v[60:63], a[212:215], v[164:167]
    v_or3_b32 v24, v24, v202, v206
    v_fma_mix_f32 v202, v202, v32, v36 op_sel_hi:[1,0,0]
    v_mfma_f32_16x16x32_bf16 v[168:171], v[60:63], a[216:219], v[168:171]
    ds_read_b128 a[240:243], v21 offset:20480
    v_mfma_f32_16x16x32_bf16 v[172:175], v[60:63], a[220:223], v[172:175]
    ds_read_b128 v[60:63], v12 offset:53248
    buffer_load_dwordx4 v11, s[8:11], s53 offen lds
    v_fma_mix_f32 v206, v206, v32, v36 op_sel_hi:[1,0,0]
    v_or3_b32 v25, v25, v203, v207
    s_waitcnt lgkmcnt(5)
    v_mfma_f32_16x16x32_bf16 v[80:83], v[40:43], a[224:227], v[80:83]
    ds_read_b128 a[244:247], v21 offset:21504
    v_fma_mix_f32 v203, v203, v33, v37 op_sel_hi:[1,0,0]
    v_mfma_f32_16x16x32_bf16 v[84:87], v[40:43], a[228:231], v[84:87]
    v_fma_mix_f32 v207, v207, v33, v37 op_sel_hi:[1,0,0]
    v_cvt_pk_bf16_f32 v65, v200, v204
    s_waitcnt lgkmcnt(3)
    v_mfma_f32_16x16x32_bf16 v[88:91], v[40:43], a[232:235], v[88:91]
    ds_read_b128 a[248:251], v21 offset:22528
    v_mfma_f32_16x16x32_bf16 v[92:95], v[40:43], a[236:239], v[92:95]
    ds_read_b128 v[40:43], v13 offset:49152
    buffer_load_dwordx4 v11, s[8:11], s58 offen offset:1024 lds
    s_add_u32 m0, s43, 106496
    v_add_u32_e32 v11, s78, v10
    v_cvt_pk_bf16_f32 v69, v201, v205
    v_mfma_f32_16x16x32_bf16 v[96:99], v[44:47], a[224:227], v[96:99]
    ds_read_b128 a[252:255], v21 offset:23552
    v_cvt_pk_bf16_f32 v73, v202, v206
    v_mfma_f32_16x16x32_bf16 v[100:103], v[44:47], a[228:231], v[100:103]
    v_cvt_pk_bf16_f32 v77, v203, v207
    s_waitcnt vmcnt(10)
    v_mfma_f32_16x16x32_bf16 v[104:107], v[44:47], a[232:235], v[104:107]
    v_or3_b32 v24, v24, v208, v212
    v_fma_mix_f32 v208, v208, v30, v34 op_sel_hi:[1,0,0]
    v_mfma_f32_16x16x32_bf16 v[108:111], v[44:47], a[236:239], v[108:111]
    ds_read_b128 v[44:47], v13 offset:53248
    v_fma_mix_f32 v212, v212, v30, v34 op_sel_hi:[1,0,0]
    s_waitcnt vmcnt(8)
    v_or3_b32 v24, v24, v216, v220
    v_fma_mix_f32 v216, v216, v30, v34 op_sel_hi:[1,0,0]
    s_waitcnt lgkmcnt(4)
    v_mfma_f32_16x16x32_bf16 v[80:83], v[48:51], a[240:243], v[80:83]
    buffer_load_dwordx4 v11, s[8:11], s53 offen lds
    v_fma_mix_f32 v220, v220, v30, v34 op_sel_hi:[1,0,0]
    v_mfma_f32_16x16x32_bf16 v[84:87], v[48:51], a[244:247], v[84:87]
    v_cvt_pk_bf16_f32 v66, v208, v212
    v_cvt_pk_bf16_f32 v67, v216, v220
    v_or3_b32 v25, v25, v209, v213
    s_waitcnt lgkmcnt(1)
    v_mfma_f32_16x16x32_bf16 v[88:91], v[48:51], a[248:251], v[88:91]
    v_mfma_f32_16x16x32_bf16 v[92:95], v[48:51], a[252:255], v[92:95]
    ds_read_b128 v[48:51], v12 offset:57344
    v_fma_mix_f32 v209, v209, v31, v35 op_sel_hi:[1,0,0]
    v_fma_mix_f32 v213, v213, v31, v35 op_sel_hi:[1,0,0]
    v_or3_b32 v25, v25, v217, v221
    v_mfma_f32_16x16x32_bf16 v[96:99], v[52:55], a[240:243], v[96:99]
    ds_write_b128 v20, v[64:67] offset:0
    v_mfma_f32_16x16x32_bf16 v[100:103], v[52:55], a[244:247], v[100:103]
    v_fma_mix_f32 v217, v217, v31, v35 op_sel_hi:[1,0,0]
    v_fma_mix_f32 v221, v221, v31, v35 op_sel_hi:[1,0,0]
    v_mfma_f32_16x16x32_bf16 v[104:107], v[52:55], a[248:251], v[104:107]
    v_cvt_pk_bf16_f32 v70, v209, v213
    buffer_load_dwordx4 v11, s[8:11], s58 offen offset:1024 lds
    v_mfma_f32_16x16x32_bf16 v[108:111], v[52:55], a[252:255], v[108:111]
    s_add_u32 m0, s43, 114688
    v_add_u32_e32 v11, s79, v10
    v_mfma_f32_16x16x32_bf16 v[112:115], v[56:59], a[224:227], v[112:115]
    v_cvt_pk_bf16_f32 v71, v217, v221
    ds_read_b128 v[52:55], v12 offset:61440
    v_mfma_f32_16x16x32_bf16 v[116:119], v[56:59], a[228:231], v[116:119]
    v_or3_b32 v24, v24, v210, v214
    v_fma_mix_f32 v210, v210, v32, v36 op_sel_hi:[1,0,0]
    v_mfma_f32_16x16x32_bf16 v[120:123], v[56:59], a[232:235], v[120:123]
    v_fma_mix_f32 v214, v214, v32, v36 op_sel_hi:[1,0,0]
    v_or3_b32 v24, v24, v218, v222
    v_mfma_f32_16x16x32_bf16 v[124:127], v[56:59], a[236:239], v[124:127]
    ds_write_b128 v20, v[68:71] offset:1024
    v_fma_mix_f32 v218, v218, v32, v36 op_sel_hi:[1,0,0]
    v_mfma_f32_16x16x32_bf16 v[128:131], v[60:63], a[224:227], v[128:131]
    v_fma_mix_f32 v222, v222, v32, v36 op_sel_hi:[1,0,0]
L_tL2:
    s_cbranch_execz L_retL
    v_cvt_pk_bf16_f32 v74, v210, v214
    v_mfma_f32_16x16x32_bf16 v[132:135], v[60:63], a[228:231], v[132:135]
    buffer_load_dwordx4 v11, s[8:11], s53 offen lds
    v_cvt_pk_bf16_f32 v75, v218, v222
    v_mfma_f32_16x16x32_bf16 v[136:139], v[60:63], a[232:235], v[136:139]
    v_or3_b32 v25, v25, v211, v215
    ds_read_b128 v[56:59], v13 offset:57344
    v_mfma_f32_16x16x32_bf16 v[140:143], v[60:63], a[236:239], v[140:143]
    ds_read_b128 v[60:63], v13 offset:61440
    buffer_load_dwordx4 v11, s[8:11], s58 offen offset:1024 lds
    s_add_u32 m0, s43, 122880
    v_add_u32_e32 v11, s80, v10
    v_fma_mix_f32 v211, v211, v33, v37 op_sel_hi:[1,0,0]
    v_mfma_f32_16x16x32_bf16 v[112:115], v[40:43], a[240:243], v[112:115]
    ds_write_b128 v20, v[72:75] offset:2048
    v_fma_mix_f32 v215, v215, v33, v37 op_sel_hi:[1,0,0]
    v_mfma_f32_16x16x32_bf16 v[116:119], v[40:43], a[244:247], v[116:119]
    v_or3_b32 v25, v25, v219, v223
    v_fma_mix_f32 v219, v219, v33, v37 op_sel_hi:[1,0,0]
    v_mfma_f32_16x16x32_bf16 v[120:123], v[40:43], a[248:251], v[120:123]
    v_fma_mix_f32 v223, v223, v33, v37 op_sel_hi:[1,0,0]
    v_cvt_pk_bf16_f32 v78, v211, v215
    v_mfma_f32_16x16x32_bf16 v[124:127], v[40:43], a[252:255], v[124:127]
    v_cvt_pk_bf16_f32 v79, v219, v223
    s_waitcnt lgkmcnt(3)
    v_mfma_f32_16x16x32_bf16 v[128:131], v[44:47], a[240:243], v[128:131]
    ds_read_b128 v[40:43], v14 offset:0
    buffer_load_dwordx4 v11, s[8:11], s53 offen lds
    v_mfma_f32_16x16x32_bf16 v[132:135], v[44:47], a[244:247], v[132:135]
    v_mfma_f32_16x16x32_bf16 v[136:139], v[44:47], a[248:251], v[136:139]
    ds_write_b128 v20, v[76:79] offset:3072
    v_mfma_f32_16x16x32_bf16 v[140:143], v[44:47], a[252:255], v[140:143]
    v_mfma_f32_16x16x32_bf16 v[144:147], v[48:51], a[224:227], v[144:147]
    buffer_load_dwordx4 v11, s[8:11], s58 offen offset:1024 lds
    s_add_u32 m0, s43, 0
    v_mfma_f32_16x16x32_bf16 v[148:151], v[48:51], a[228:231], v[148:151]
    v_add_u32_e32 v11, s81, v10
    v_mfma_f32_16x16x32_bf16 v[152:155], v[48:51], a[232:235], v[152:155]
    ds_read_b128 v[44:47], v14 offset:4096
    v_mfma_f32_16x16x32_bf16 v[156:159], v[48:51], a[236:239], v[156:159]
    ds_read_b128 v[48:51], v15 offset:0
    v_mfma_f32_16x16x32_bf16 v[160:163], v[52:55], a[224:227], v[160:163]
    v_mfma_f32_16x16x32_bf16 v[164:167], v[52:55], a[228:231], v[164:167]
    s_waitcnt vmcnt(10) lgkmcnt(2)
    s_barrier
    v_mfma_f32_16x16x32_bf16 v[168:171], v[52:55], a[232:235], v[168:171]
    ds_read_b128 v[224:227], v21 offset:0
    v_mfma_f32_16x16x32_bf16 v[172:175], v[52:55], a[236:239], v[172:175]
    ds_read_b128 v[52:55], v15 offset:4096
    buffer_load_dwordx4 v11, s[8:11], s53 offen lds
    v_or_b32_e32 v24, v24, v25
    v_cmp_lt_u32_e32 vcc, 15, v24
    s_or_b64 s[48:49], s[46:47], vcc
    s_cmp_lg_u64 s[48:49], 0
    s_cselect_b32 s36, 1, 0
    v_mfma_f32_16x16x32_bf16 v[144:147], v[56:59], a[240:243], v[144:147]
    ds_read_b128 v[228:231], v21 offset:1024
    v_lshlrev_b32_e32 v3, 2, v1
    v_mfma_f32_16x16x32_bf16 v[148:151], v[56:59], a[244:247], v[148:151]
    v_mov_b32_e32 v4, s36
    v_add_u32_e32 v3, 147456, v3
    v_mov_b32_e32 v5, 147456
    s_mov_b32 vcc_lo, 0xff00ff
    v_mfma_f32_16x16x32_bf16 v[152:155], v[56:59], a[248:251], v[152:155]
    s_mov_b32 vcc_hi, 0xff00ff
    ds_read_b128 v[232:235], v21 offset:2048
    v_mfma_f32_16x16x32_bf16 v[156:159], v[56:59], a[252:255], v[156:159]
    ds_read_b128 v[56:59], v14 offset:8192
    buffer_load_dwordx4 v11, s[8:11], s58 offen offset:1024 lds
    s_add_u32 m0, s43, 8192
    v_mfma_f32_16x16x32_bf16 v[160:163], v[60:63], a[240:243], v[160:163]
    v_add_u32_e32 v11, s82, v10
    ds_read_b128 v[236:239], v21 offset:3072
    v_mfma_f32_16x16x32_bf16 v[164:167], v[60:63], a[244:247], v[164:167]
    v_mfma_f32_16x16x32_bf16 v[168:171], v[60:63], a[248:251], v[168:171]
    ds_read_b128 v[240:243], v21 offset:4096
    v_mfma_f32_16x16x32_bf16 v[172:175], v[60:63], a[252:255], v[172:175]
    ds_read_b128 v[60:63], v14 offset:12288
    s_waitcnt lgkmcnt(5)
    v_mfma_f32_16x16x32_bf16 v[80:83], v[40:43], v[224:227], v[80:83]
    ds_read_b128 v[244:247], v21 offset:5120
    buffer_load_dwordx4 v11, s[8:11], s53 offen lds
    v_mfma_f32_16x16x32_bf16 v[84:87], v[40:43], v[228:231], v[84:87]
    s_waitcnt lgkmcnt(3)
    v_mfma_f32_16x16x32_bf16 v[88:91], v[40:43], v[232:235], v[88:91]
    ds_read_b128 v[248:251], v21 offset:6144
    v_mfma_f32_16x16x32_bf16 v[92:95], v[40:43], v[236:239], v[92:95]
    ds_read_b128 v[40:43], v15 offset:8192
    v_mfma_f32_16x16x32_bf16 v[96:99], v[44:47], v[224:227], v[96:99]
    ds_read_b128 v[252:255], v21 offset:7168
    buffer_load_dwordx4 v11, s[8:11], s58 offen offset:1024 lds
    v_mfma_f32_16x16x32_bf16 v[100:103], v[44:47], v[228:231], v[100:103]
    s_add_u32 m0, s43, 16384
    v_add_u32_e32 v11, s83, v10
    v_mfma_f32_16x16x32_bf16 v[104:107], v[44:47], v[232:235], v[104:107]
    ds_write_b32 v3, v4
    v_mfma_f32_16x16x32_bf16 v[108:111], v[44:47], v[236:239], v[108:111]
    ds_read_b128 v[44:47], v15 offset:12288
    s_waitcnt lgkmcnt(5)
    v_mfma_f32_16x16x32_bf16 v[80:83], v[48:51], v[240:243], v[80:83]
    v_mfma_f32_16x16x32_bf16 v[84:87], v[48:51], v[244:247], v[84:87]
    s_waitcnt lgkmcnt(2)
    v_mfma_f32_16x16x32_bf16 v[88:91], v[48:51], v[248:251], v[88:91]
    v_mfma_f32_16x16x32_bf16 v[92:95], v[48:51], v[252:255], v[92:95]
    ds_read_b128 v[48:51], v14 offset:16384
    buffer_load_dwordx4 v11, s[8:11], s53 offen lds
    v_mfma_f32_16x16x32_bf16 v[96:99], v[52:55], v[240:243], v[96:99]
    v_mfma_f32_16x16x32_bf16 v[100:103], v[52:55], v[244:247], v[100:103]
    v_mfma_f32_16x16x32_bf16 v[104:107], v[52:55], v[248:251], v[104:107]
    v_mfma_f32_16x16x32_bf16 v[108:111], v[52:55], v[252:255], v[108:111]
    ds_read_b128 v[52:55], v14 offset:20480
    buffer_load_dwordx4 v11, s[8:11], s58 offen offset:1024 lds
    v_lshl_add_u32 v23, s85, 3, v22
    v_cvt_pk_bf16_f32 v80, v80, v84
    v_cvt_pk_bf16_f32 v81, v81, v85
    v_mfma_f32_16x16x32_bf16 v[112:115], v[56:59], v[224:227], v[112:115]
    v_cvt_pk_bf16_f32 v82, v82, v86
    v_cvt_pk_bf16_f32 v83, v83, v87
    v_mfma_f32_16x16x32_bf16 v[116:119], v[56:59], v[228:231], v[116:119]
    v_cvt_pk_bf16_f32 v88, v88, v92
    v_cvt_pk_bf16_f32 v89, v89, v93
    v_mfma_f32_16x16x32_bf16 v[120:123], v[56:59], v[232:235], v[120:123]
    v_cvt_pk_bf16_f32 v90, v90, v94
    v_cvt_pk_bf16_f32 v91, v91, v95
    v_mfma_f32_16x16x32_bf16 v[124:127], v[56:59], v[236:239], v[124:127]
    v_cndmask_b32_dpp v84, v81, v80, vcc row_ror:8 row_mask:0xf bank_mask:0xf
    ds_read_b128 v[56:59], v15 offset:16384
    v_mfma_f32_16x16x32_bf16 v[128:131], v[60:63], v[224:227], v[128:131]
    v_cndmask_b32_dpp v85, v89, v88, vcc row_ror:8 row_mask:0xf bank_mask:0xf
    s_not_b64 vcc, vcc
    v_mfma_f32_16x16x32_bf16 v[132:135], v[60:63], v[228:231], v[132:135]
    v_cndmask_b32_dpp v86, v80, v81, vcc row_ror:8 row_mask:0xf bank_mask:0xf
    v_cndmask_b32_dpp v87, v88, v89, vcc row_ror:8 row_mask:0xf bank_mask:0xf
    v_mfma_f32_16x16x32_bf16 v[136:139], v[60:63], v[232:235], v[136:139]
    buffer_store_dwordx4 v[84:87], v23, s[24:27], 0 offen sc1
    v_cndmask_b32_dpp v94, v82, v83, vcc row_ror:8 row_mask:0xf bank_mask:0xf
    v_mfma_f32_16x16x32_bf16 v[140:143], v[60:63], v[236:239], v[140:143]
    v_cndmask_b32_dpp v95, v90, v91, vcc row_ror:8 row_mask:0xf bank_mask:0xf
    s_not_b64 vcc, vcc
    v_mfma_f32_16x16x32_bf16 v[112:115], v[40:43], v[240:243], v[112:115]
    v_cndmask_b32_dpp v92, v83, v82, vcc row_ror:8 row_mask:0xf bank_mask:0xf
    v_cndmask_b32_dpp v93, v91, v90, vcc row_ror:8 row_mask:0xf bank_mask:0xf
    v_mfma_f32_16x16x32_bf16 v[116:119], v[40:43], v[244:247], v[116:119]
    s_add_u32 m0, s43, 24576
    v_add_u32_e32 v11, s84, v10
    v_mfma_f32_16x16x32_bf16 v[120:123], v[40:43], v[248:251], v[120:123]
    ds_read_b128 v[60:63], v15 offset:20480
    buffer_load_dwordx4 v11, s[8:11], s53 offen lds
    v_mfma_f32_16x16x32_bf16 v[124:127], v[40:43], v[252:255], v[124:127]
    buffer_load_dwordx4 v11, s[8:11], s58 offen offset:1024 lds
    s_waitcnt lgkmcnt(1)
    v_mfma_f32_16x16x32_bf16 v[128:131], v[44:47], v[240:243], v[128:131]
    v_mfma_f32_16x16x32_bf16 v[132:135], v[44:47], v[244:247], v[132:135]
    s_waitcnt vmcnt(9)
    s_barrier
    v_mfma_f32_16x16x32_bf16 v[136:139], v[44:47], v[248:251], v[136:139]
    ds_read_b128 v[40:43], v14 offset:24576
    v_mfma_f32_16x16x32_bf16 v[140:143], v[44:47], v[252:255], v[140:143]
    ds_read_b128 v[44:47], v14 offset:28672
    buffer_store_dwordx4 v[92:95], v23, s[24:27], s73 offen sc1
    ds_read_b128 v[4:7], v5
    v_mfma_f32_16x16x32_bf16 v[144:147], v[48:51], v[224:227], v[144:147]
    v_cvt_pk_bf16_f32 v96, v96, v100
    v_cvt_pk_bf16_f32 v97, v97, v101
    v_mfma_f32_16x16x32_bf16 v[148:151], v[48:51], v[228:231], v[148:151]
    v_cvt_pk_bf16_f32 v98, v98, v102
    v_cvt_pk_bf16_f32 v99, v99, v103
    v_mfma_f32_16x16x32_bf16 v[152:155], v[48:51], v[232:235], v[152:155]
    v_cvt_pk_bf16_f32 v104, v104, v108
    v_cvt_pk_bf16_f32 v105, v105, v109
    v_mfma_f32_16x16x32_bf16 v[156:159], v[48:51], v[236:239], v[156:159]
    ds_read_b128 v[48:51], v15 offset:24576
    v_cvt_pk_bf16_f32 v106, v106, v110
    v_mfma_f32_16x16x32_bf16 v[160:163], v[52:55], v[224:227], v[160:163]
    v_cvt_pk_bf16_f32 v107, v107, v111
    v_cndmask_b32_dpp v100, v97, v96, vcc row_ror:8 row_mask:0xf bank_mask:0xf
    v_mfma_f32_16x16x32_bf16 v[164:167], v[52:55], v[228:231], v[164:167]
    v_cndmask_b32_dpp v101, v105, v104, vcc row_ror:8 row_mask:0xf bank_mask:0xf
    s_not_b64 vcc, vcc
    v_mfma_f32_16x16x32_bf16 v[168:171], v[52:55], v[232:235], v[168:171]
    v_cndmask_b32_dpp v102, v96, v97, vcc row_ror:8 row_mask:0xf bank_mask:0xf
    v_cndmask_b32_dpp v103, v104, v105, vcc row_ror:8 row_mask:0xf bank_mask:0xf
    v_mfma_f32_16x16x32_bf16 v[172:175], v[52:55], v[236:239], v[172:175]
    ds_read_b128 v[52:55], v15 offset:28672
    s_waitcnt lgkmcnt(2)
    v_or3_b32 v4, v4, v5, v6
    v_or_b32_e32 v4, v4, v7
    s_nop 0
    v_readfirstlane_b32_e32 s36, v4
    s_cmp_lg_u32 s36, 0
    s_cbranch_scc1 L_slow
    v_mfma_f32_16x16x32_bf16 v[144:147], v[56:59], v[240:243], v[144:147]
    v_mfma_f32_16x16x32_bf16 v[148:151], v[56:59], v[244:247], v[148:151]
    v_mfma_f32_16x16x32_bf16 v[152:155], v[56:59], v[248:251], v[152:155]
    v_mfma_f32_16x16x32_bf16 v[156:159], v[56:59], v[252:255], v[156:159]
    ds_read_b128 v[56:59], v14 offset:32768
    v_mfma_f32_16x16x32_bf16 v[160:163], v[60:63], v[240:243], v[160:163]
    buffer_store_dwordx4 v[100:103], v23, s[24:27], s74 offen sc1
    v_mfma_f32_16x16x32_bf16 v[164:167], v[60:63], v[244:247], v[164:167]
    v_mfma_f32_16x16x32_bf16 v[168:171], v[60:63], v[248:251], v[168:171]
    v_mfma_f32_16x16x32_bf16 v[172:175], v[60:63], v[252:255], v[172:175]
    ds_read_b128 v[60:63], v14 offset:36864
    v_cndmask_b32_dpp v110, v98, v99, vcc row_ror:8 row_mask:0xf bank_mask:0xf
    v_mfma_f32_16x16x32_bf16 v[176:179], v[40:43], a[0:3], 0
    v_cndmask_b32_dpp v111, v106, v107, vcc row_ror:8 row_mask:0xf bank_mask:0xf
    s_not_b64 vcc, vcc
    v_mfma_f32_16x16x32_bf16 v[180:183], v[40:43], a[4:7], 0
    v_cndmask_b32_dpp v108, v99, v98, vcc row_ror:8 row_mask:0xf bank_mask:0xf
    v_cndmask_b32_dpp v109, v107, v106, vcc row_ror:8 row_mask:0xf bank_mask:0xf
    v_mfma_f32_16x16x32_bf16 v[184:187], v[40:43], a[8:11], 0
    v_mfma_f32_16x16x32_bf16 v[188:191], v[40:43], a[12:15], 0
    ds_read_b128 v[40:43], v15 offset:32768
    v_mfma_f32_16x16x32_bf16 v[192:195], v[44:47], a[0:3], 0
    v_mfma_f32_16x16x32_bf16 v[196:199], v[44:47], a[4:7], 0
    v_mfma_f32_16x16x32_bf16 v[200:203], v[44:47], a[8:11], 0
    v_mfma_f32_16x16x32_bf16 v[204:207], v[44:47], a[12:15], 0
    ds_read_b128 v[44:47], v15 offset:36864
    s_waitcnt lgkmcnt(2)
    v_mfma_f32_16x16x32_bf16 v[176:179], v[48:51], a[16:19], v[176:179]
    v_mfma_f32_16x16x32_bf16 v[180:183], v[48:51], a[20:23], v[180:183]
    v_mfma_f32_16x16x32_bf16 v[184:187], v[48:51], a[24:27], v[184:187]
    v_mfma_f32_16x16x32_bf16 v[188:191], v[48:51], a[28:31], v[188:191]
    ds_read_b128 v[48:51], v14 offset:40960
    buffer_store_dwordx4 v[108:111], v23, s[24:27], s75 offen sc1
    v_mfma_f32_16x16x32_bf16 v[192:195], v[52:55], a[16:19], v[192:195]
    v_mfma_f32_16x16x32_bf16 v[196:199], v[52:55], a[20:23], v[196:199]
    s_nop 0
    v_lshl_add_u32 v23, s86, 3, v22
    v_mfma_f32_16x16x32_bf16 v[200:203], v[52:55], a[24:27], v[200:203]
    v_cvt_pk_bf16_f32 v112, v112, v116
    v_cvt_pk_bf16_f32 v113, v113, v117
    v_mfma_f32_16x16x32_bf16 v[204:207], v[52:55], a[28:31], v[204:207]
    v_cvt_pk_bf16_f32 v114, v114, v118
    v_cvt_pk_bf16_f32 v115, v115, v119
    v_mfma_f32_16x16x32_bf16 v[176:179], v[56:59], a[32:35], v[176:179]
    ds_read_b128 v[52:55], v14 offset:45056
    v_cvt_pk_bf16_f32 v120, v120, v124
    v_mfma_f32_16x16x32_bf16 v[180:183], v[56:59], a[36:39], v[180:183]
    v_cvt_pk_bf16_f32 v121, v121, v125
    v_cvt_pk_bf16_f32 v122, v122, v126
    v_mfma_f32_16x16x32_bf16 v[184:187], v[56:59], a[40:43], v[184:187]
    v_cvt_pk_bf16_f32 v123, v123, v127
    v_cndmask_b32_dpp v116, v113, v112, vcc row_ror:8 row_mask:0xf bank_mask:0xf
    v_mfma_f32_16x16x32_bf16 v[188:191], v[56:59], a[44:47], v[188:191]
    v_cndmask_b32_dpp v117, v121, v120, vcc row_ror:8 row_mask:0xf bank_mask:0xf
    s_not_b64 vcc, vcc
    v_mfma_f32_16x16x32_bf16 v[192:195], v[60:63], a[32:35], v[192:195]
    v_cndmask_b32_dpp v118, v112, v113, vcc row_ror:8 row_mask:0xf bank_mask:0xf
    v_cndmask_b32_dpp v119, v120, v121, vcc row_ror:8 row_mask:0xf bank_mask:0xf
    v_mfma_f32_16x16x32_bf16 v[196:199], v[60:63], a[36:39], v[196:199]
    ds_read_b128 v[56:59], v15 offset:40960
    v_mfma_f32_16x16x32_bf16 v[200:203], v[60:63], a[40:43], v[200:203]
    v_mfma_f32_16x16x32_bf16 v[204:207], v[60:63], a[44:47], v[204:207]
    ds_read_b128 v[60:63], v15 offset:45056
    s_waitcnt lgkmcnt(2)
    v_mfma_f32_16x16x32_bf16 v[176:179], v[40:43], a[48:51], v[176:179]
    buffer_store_dwordx4 v[116:119], v23, s[24:27], 0 offen sc1
    v_mfma_f32_16x16x32_bf16 v[180:183], v[40:43], a[52:55], v[180:183]
    v_mfma_f32_16x16x32_bf16 v[184:187], v[40:43], a[56:59], v[184:187]
    v_mfma_f32_16x16x32_bf16 v[188:191], v[40:43], a[60:63], v[188:191]
    ds_read_b128 v[40:43], v14 offset:49152
    v_cndmask_b32_dpp v126, v114, v115, vcc row_ror:8 row_mask:0xf bank_mask:0xf
    v_mfma_f32_16x16x32_bf16 v[192:195], v[44:47], a[48:51], v[192:195]
    v_cndmask_b32_dpp v127, v122, v123, vcc row_ror:8 row_mask:0xf bank_mask:0xf
    s_not_b64 vcc, vcc
    v_mfma_f32_16x16x32_bf16 v[196:199], v[44:47], a[52:55], v[196:199]
    v_cndmask_b32_dpp v124, v115, v114, vcc row_ror:8 row_mask:0xf bank_mask:0xf
    v_cndmask_b32_dpp v125, v123, v122, vcc row_ror:8 row_mask:0xf bank_mask:0xf
    v_mfma_f32_16x16x32_bf16 v[200:203], v[44:47], a[56:59], v[200:203]
    v_mfma_f32_16x16x32_bf16 v[204:207], v[44:47], a[60:63], v[204:207]
    ds_read_b128 v[44:47], v14 offset:53248
    v_mfma_f32_16x16x32_bf16 v[176:179], v[48:51], a[64:67], v[176:179]
    v_mfma_f32_16x16x32_bf16 v[180:183], v[48:51], a[68:71], v[180:183]
    v_mfma_f32_16x16x32_bf16 v[184:187], v[48:51], a[72:75], v[184:187]
    v_mfma_f32_16x16x32_bf16 v[188:191], v[48:51], a[76:79], v[188:191]
    ds_read_b128 v[48:51], v15 offset:49152
    v_mfma_f32_16x16x32_bf16 v[192:195], v[52:55], a[64:67], v[192:195]
    v_mfma_f32_16x16x32_bf16 v[196:199], v[52:55], a[68:71], v[196:199]
    v_mfma_f32_16x16x32_bf16 v[200:203], v[52:55], a[72:75], v[200:203]
    v_mfma_f32_16x16x32_bf16 v[204:207], v[52:55], a[76:79], v[204:207]
    ds_read_b128 v[52:55], v15 offset:53248
    buffer_store_dwordx4 v[124:127], v23, s[24:27], s73 offen sc1
    s_waitcnt lgkmcnt(2)
    v_mfma_f32_16x16x32_bf16 v[176:179], v[56:59], a[80:83], v[176:179]
    v_cvt_pk_bf16_f32 v128, v128, v132
    v_cvt_pk_bf16_f32 v129, v129, v133
    v_mfma_f32_16x16x32_bf16 v[180:183], v[56:59], a[84:87], v[180:183]
    v_cvt_pk_bf16_f32 v130, v130, v134
    v_cvt_pk_bf16_f32 v131, v131, v135
    v_mfma_f32_16x16x32_bf16 v[184:187], v[56:59], a[88:91], v[184:187]
    v_cvt_pk_bf16_f32 v136, v136, v140
    v_cvt_pk_bf16_f32 v137, v137, v141
    v_mfma_f32_16x16x32_bf16 v[188:191], v[56:59], a[92:95], v[188:191]
    ds_read_b128 v[56:59], v14 offset:57344
    v_cvt_pk_bf16_f32 v138, v138, v142
    v_mfma_f32_16x16x32_bf16 v[192:195], v[60:63], a[80:83], v[192:195]
    v_cvt_pk_bf16_f32 v139, v139, v143
    v_cndmask_b32_dpp v132, v129, v128, vcc row_ror:8 row_mask:0xf bank_mask:0xf
    v_mfma_f32_16x16x32_bf16 v[196:199], v[60:63], a[84:87], v[196:199]
    v_cndmask_b32_dpp v133, v137, v136, vcc row_ror:8 row_mask:0xf bank_mask:0xf
    s_not_b64 vcc, vcc
    v_mfma_f32_16x16x32_bf16 v[200:203], v[60:63], a[88:91], v[200:203]
    v_cndmask_b32_dpp v134, v128, v129, vcc row_ror:8 row_mask:0xf bank_mask:0xf
    v_cndmask_b32_dpp v135, v136, v137, vcc row_ror:8 row_mask:0xf bank_mask:0xf
    v_mfma_f32_16x16x32_bf16 v[204:207], v[60:63], a[92:95], v[204:207]
    ds_read_b128 v[60:63], v14 offset:61440
    v_mfma_f32_16x16x32_bf16 v[176:179], v[40:43], a[96:99], v[176:179]
    v_mfma_f32_16x16x32_bf16 v[180:183], v[40:43], a[100:103], v[180:183]
    v_mfma_f32_16x16x32_bf16 v[184:187], v[40:43], a[104:107], v[184:187]
    v_mfma_f32_16x16x32_bf16 v[188:191], v[40:43], a[108:111], v[188:191]
    ds_read_b128 v[40:43], v15 offset:57344
    v_mfma_f32_16x16x32_bf16 v[192:195], v[44:47], a[96:99], v[192:195]
    v_mfma_f32_16x16x32_bf16 v[196:199], v[44:47], a[100:103], v[196:199]
    s_waitcnt vmcnt(5)
    s_barrier
    v_mfma_f32_16x16x32_bf16 v[200:203], v[44:47], a[104:107], v[200:203]
    v_mfma_f32_16x16x32_bf16 v[204:207], v[44:47], a[108:111], v[204:207]
    ds_read_b128 v[44:47], v15 offset:61440
    buffer_store_dwordx4 v[132:135], v23, s[24:27], s74 offen sc1
    s_waitcnt lgkmcnt(2)
    v_mfma_f32_16x16x32_bf16 v[176:179], v[48:51], a[112:115], v[176:179]
    v_cndmask_b32_dpp v142, v130, v131, vcc row_ror:8 row_mask:0xf bank_mask:0xf
    v_cndmask_b32_dpp v143, v138, v139, vcc row_ror:8 row_mask:0xf bank_mask:0xf
    v_mfma_f32_16x16x32_bf16 v[180:183], v[48:51], a[116:119], v[180:183]
    s_not_b64 vcc, vcc
    v_cndmask_b32_dpp v140, v131, v130, vcc row_ror:8 row_mask:0xf bank_mask:0xf
    v_mfma_f32_16x16x32_bf16 v[184:187], v[48:51], a[120:123], v[184:187]
    v_cndmask_b32_dpp v141, v139, v138, vcc row_ror:8 row_mask:0xf bank_mask:0xf
    v_mfma_f32_16x16x32_bf16 v[188:191], v[48:51], a[124:127], v[188:191]
    ds_read_b128 v[48:51], v12 offset:0
    v_mfma_f32_16x16x32_bf16 v[192:195], v[52:55], a[112:115], v[192:195]
    v_mfma_f32_16x16x32_bf16 v[196:199], v[52:55], a[116:119], v[196:199]
    v_mfma_f32_16x16x32_bf16 v[200:203], v[52:55], a[120:123], v[200:203]
    v_mfma_f32_16x16x32_bf16 v[204:207], v[52:55], a[124:127], v[204:207]
    ds_read_b128 v[52:55], v12 offset:4096
    v_mfma_f32_16x16x32_bf16 v[176:179], v[56:59], a[128:131], v[176:179]
    v_mfma_f32_16x16x32_bf16 v[180:183], v[56:59], a[132:135], v[180:183]
    v_mfma_f32_16x16x32_bf16 v[184:187], v[56:59], a[136:139], v[184:187]
    v_mfma_f32_16x16x32_bf16 v[188:191], v[56:59], a[140:143], v[188:191]
    ds_read_b128 v[56:59], v13 offset:0
    buffer_store_dwordx4 v[140:143], v23, s[24:27], s75 offen sc1
    v_mfma_f32_16x16x32_bf16 v[192:195], v[60:63], a[128:131], v[192:195]
    v_mfma_f32_16x16x32_bf16 v[196:199], v[60:63], a[132:135], v[196:199]
    s_nop 0
    v_lshl_add_u32 v23, s87, 3, v22
    v_cvt_pk_bf16_f32 v144, v144, v148
    v_cvt_pk_bf16_f32 v145, v145, v149
    v_mfma_f32_16x16x32_bf16 v[200:203], v[60:63], a[136:139], v[200:203]
    v_cvt_pk_bf16_f32 v146, v146, v150
    v_cvt_pk_bf16_f32 v147, v147, v151
    v_mfma_f32_16x16x32_bf16 v[204:207], v[60:63], a[140:143], v[204:207]
    ds_read_b128 v[60:63], v13 offset:4096
    v_cvt_pk_bf16_f32 v152, v152, v156
    v_cvt_pk_bf16_f32 v153, v153, v157
    v_cvt_pk_bf16_f32 v154, v154, v158
    v_cvt_pk_bf16_f32 v155, v155, v159
    s_waitcnt lgkmcnt(2)
    v_mfma_f32_16x16x32_bf16 v[176:179], v[40:43], a[144:147], v[176:179]
    v_cndmask_b32_dpp v148, v145, v144, vcc row_ror:8 row_mask:0xf bank_mask:0xf
    v_cndmask_b32_dpp v149, v153, v152, vcc row_ror:8 row_mask:0xf bank_mask:0xf
    v_mfma_f32_16x16x32_bf16 v[180:183], v[40:43], a[148:151], v[180:183]
    s_not_b64 vcc, vcc
    v_cndmask_b32_dpp v150, v144, v145, vcc row_ror:8 row_mask:0xf bank_mask:0xf
    v_mfma_f32_16x16x32_bf16 v[184:187], v[40:43], a[152:155], v[184:187]
    v_cndmask_b32_dpp v151, v152, v153, vcc row_ror:8 row_mask:0xf bank_mask:0xf
    v_mfma_f32_16x16x32_bf16 v[188:191], v[40:43], a[156:159], v[188:191]
    ds_read_b128 v[40:43], v12 offset:8192
    v_mfma_f32_16x16x32_bf16 v[192:195], v[44:47], a[144:147], v[192:195]
    v_mfma_f32_16x16x32_bf16 v[196:199], v[44:47], a[148:151], v[196:199]
    v_mfma_f32_16x16x32_bf16 v[200:203], v[44:47], a[152:155], v[200:203]
    v_mfma_f32_16x16x32_bf16 v[204:207], v[44:47], a[156:159], v[204:207]
    ds_read_b128 v[44:47], v12 offset:12288
    v_mfma_f32_16x16x32_bf16 v[176:179], v[48:51], a[160:163], v[176:179]
    buffer_store_dwordx4 v[148:151], v23, s[24:27], 0 offen sc1
    v_mfma_f32_16x16x32_bf16 v[180:183], v[48:51], a[164:167], v[180:183]
    v_mfma_f32_16x16x32_bf16 v[184:187], v[48:51], a[168:171], v[184:187]
    v_mfma_f32_16x16x32_bf16 v[188:191], v[48:51], a[172:175], v[188:191]
    ds_read_b128 v[48:51], v13 offset:8192
    v_cndmask_b32_dpp v158, v146, v147, vcc row_ror:8 row_mask:0xf bank_mask:0xf
    v_mfma_f32_16x16x32_bf16 v[192:195], v[52:55], a[160:163], v[192:195]
    v_cndmask_b32_dpp v159, v154, v155, vcc row_ror:8 row_mask:0xf bank_mask:0xf
    s_not_b64 vcc, vcc
    v_mfma_f32_16x16x32_bf16 v[196:199], v[52:55], a[164:167], v[196:199]
    v_cndmask_b32_dpp v156, v147, v146, vcc row_ror:8 row_mask:0xf bank_mask:0xf
    v_cndmask_b32_dpp v157, v155, v154, vcc row_ror:8 row_mask:0xf bank_mask:0xf
    v_mfma_f32_16x16x32_bf16 v[200:203], v[52:55], a[168:171], v[200:203]
    v_mfma_f32_16x16x32_bf16 v[204:207], v[52:55], a[172:175], v[204:207]
    ds_read_b128 v[52:55], v13 offset:12288
    s_waitcnt lgkmcnt(2)
    v_mfma_f32_16x16x32_bf16 v[176:179], v[56:59], a[176:179], v[176:179]
    v_mfma_f32_16x16x32_bf16 v[180:183], v[56:59], a[180:183], v[180:183]
    v_mfma_f32_16x16x32_bf16 v[184:187], v[56:59], a[184:187], v[184:187]
    v_mfma_f32_16x16x32_bf16 v[188:191], v[56:59], a[188:191], v[188:191]
    ds_read_b128 v[56:59], v12 offset:16384
    v_mfma_f32_16x16x32_bf16 v[192:195], v[60:63], a[176:179], v[192:195]
    v_mfma_f32_16x16x32_bf16 v[196:199], v[60:63], a[180:183], v[196:199]
    v_mfma_f32_16x16x32_bf16 v[200:203], v[60:63], a[184:187], v[200:203]
    v_mfma_f32_16x16x32_bf16 v[204:207], v[60:63], a[188:191], v[204:207]
    ds_read_b128 v[60:63], v12 offset:20480
    buffer_store_dwordx4 v[156:159], v23, s[24:27], s73 offen sc1
    v_mfma_f32_16x16x32_bf16 v[176:179], v[40:43], a[192:195], v[176:179]
    v_cvt_pk_bf16_f32 v160, v160, v164
    v_cvt_pk_bf16_f32 v161, v161, v165
    v_mfma_f32_16x16x32_bf16 v[180:183], v[40:43], a[196:199], v[180:183]
    v_cvt_pk_bf16_f32 v162, v162, v166
    v_cvt_pk_bf16_f32 v163, v163, v167
    v_mfma_f32_16x16x32_bf16 v[184:187], v[40:43], a[200:203], v[184:187]
    v_cvt_pk_bf16_f32 v168, v168, v172
    v_cvt_pk_bf16_f32 v169, v169, v173
    v_mfma_f32_16x16x32_bf16 v[188:191], v[40:43], a[204:207], v[188:191]
    ds_read_b128 v[40:43], v13 offset:16384
    v_cvt_pk_bf16_f32 v170, v170, v174
    v_mfma_f32_16x16x32_bf16 v[192:195], v[44:47], a[192:195], v[192:195]
    v_cvt_pk_bf16_f32 v171, v171, v175
    v_cndmask_b32_dpp v164, v161, v160, vcc row_ror:8 row_mask:0xf bank_mask:0xf
    v_mfma_f32_16x16x32_bf16 v[196:199], v[44:47], a[196:199], v[196:199]
    v_cndmask_b32_dpp v165, v169, v168, vcc row_ror:8 row_mask:0xf bank_mask:0xf
    s_not_b64 vcc, vcc
    v_mfma_f32_16x16x32_bf16 v[200:203], v[44:47], a[200:203], v[200:203]
    v_cndmask_b32_dpp v166, v160, v161, vcc row_ror:8 row_mask:0xf bank_mask:0xf
    v_cndmask_b32_dpp v167, v168, v169, vcc row_ror:8 row_mask:0xf bank_mask:0xf
    v_mfma_f32_16x16x32_bf16 v[204:207], v[44:47], a[204:207], v[204:207]
    ds_read_b128 v[44:47], v13 offset:20480
    s_waitcnt lgkmcnt(2)
    v_mfma_f32_16x16x32_bf16 v[176:179], v[48:51], a[208:211], v[176:179]
    v_mfma_f32_16x16x32_bf16 v[180:183], v[48:51], a[212:215], v[180:183]
    v_mfma_f32_16x16x32_bf16 v[184:187], v[48:51], a[216:219], v[184:187]
    v_mfma_f32_16x16x32_bf16 v[188:191], v[48:51], a[220:223], v[188:191]
    ds_read_b128 v[48:51], v12 offset:24576
    v_mfma_f32_16x16x32_bf16 v[192:195], v[52:55], a[208:211], v[192:195]
    buffer_store_dwordx4 v[164:167], v23, s[24:27], s74 offen sc1
    v_mfma_f32_16x16x32_bf16 v[196:199], v[52:55], a[212:215], v[196:199]
    v_mfma_f32_16x16x32_bf16 v[200:203], v[52:55], a[216:219], v[200:203]
    v_mfma_f32_16x16x32_bf16 v[204:207], v[52:55], a[220:223], v[204:207]
    ds_read_b128 v[52:55], v13 offset:24576
    v_cndmask_b32_dpp v174, v162, v163, vcc row_ror:8 row_mask:0xf bank_mask:0xf
    v_mfma_f32_16x16x32_bf16 v[176:179], v[56:59], a[224:227], v[176:179]
    v_cndmask_b32_dpp v175, v170, v171, vcc row_ror:8 row_mask:0xf bank_mask:0xf
    s_not_b64 vcc, vcc
    v_mfma_f32_16x16x32_bf16 v[180:183], v[56:59], a[228:231], v[180:183]
    v_cndmask_b32_dpp v172, v163, v162, vcc row_ror:8 row_mask:0xf bank_mask:0xf
    v_cndmask_b32_dpp v173, v171, v170, vcc row_ror:8 row_mask:0xf bank_mask:0xf
    v_mfma_f32_16x16x32_bf16 v[184:187], v[56:59], a[232:235], v[184:187]
    v_mfma_f32_16x16x32_bf16 v[188:191], v[56:59], a[236:239], v[188:191]
    ds_read_b128 v[56:59], v12 offset:28672
    v_mfma_f32_16x16x32_bf16 v[192:195], v[60:63], a[224:227], v[192:195]
    v_mfma_f32_16x16x32_bf16 v[196:199], v[60:63], a[228:231], v[196:199]
    v_mfma_f32_16x16x32_bf16 v[200:203], v[60:63], a[232:235], v[200:203]
    v_mfma_f32_16x16x32_bf16 v[204:207], v[60:63], a[236:239], v[204:207]
    ds_read_b128 v[60:63], v13 offset:28672
    s_waitcnt lgkmcnt(2)
    v_mfma_f32_16x16x32_bf16 v[176:179], v[40:43], a[240:243], v[176:179]
    v_mfma_f32_16x16x32_bf16 v[180:183], v[40:43], a[244:247], v[180:183]
    v_mfma_f32_16x16x32_bf16 v[184:187], v[40:43], a[248:251], v[184:187]
    buffer_store_dwordx4 v[172:175], v23, s[24:27], s75 offen sc1
    v_mfma_f32_16x16x32_bf16 v[188:191], v[40:43], a[252:255], v[188:191]
    v_mfma_f32_16x16x32_bf16 v[192:195], v[44:47], a[240:243], v[192:195]
    v_mfma_f32_16x16x32_bf16 v[196:199], v[44:47], a[244:247], v[196:199]
    v_mfma_f32_16x16x32_bf16 v[200:203], v[44:47], a[248:251], v[200:203]
    v_mfma_f32_16x16x32_bf16 v[204:207], v[44:47], a[252:255], v[204:207]
    v_mfma_f32_16x16x32_bf16 v[176:179], v[48:51], v[224:227], v[176:179]
    v_mfma_f32_16x16x32_bf16 v[180:183], v[48:51], v[228:231], v[180:183]
    v_mfma_f32_16x16x32_bf16 v[184:187], v[48:51], v[232:235], v[184:187]
    v_mfma_f32_16x16x32_bf16 v[188:191], v[48:51], v[236:239], v[188:191]
    v_mfma_f32_16x16x32_bf16 v[176:179], v[52:55], v[240:243], v[176:179]
    v_mfma_f32_16x16x32_bf16 v[180:183], v[52:55], v[244:247], v[180:183]
    v_mfma_f32_16x16x32_bf16 v[184:187], v[52:55], v[248:251], v[184:187]
    v_mfma_f32_16x16x32_bf16 v[188:191], v[52:55], v[252:255], v[188:191]
    s_waitcnt lgkmcnt(0)
    v_mfma_f32_16x16x32_bf16 v[192:195], v[56:59], v[224:227], v[192:195]
    v_mfma_f32_16x16x32_bf16 v[196:199], v[56:59], v[228:231], v[196:199]
    v_mfma_f32_16x16x32_bf16 v[200:203], v[56:59], v[232:235], v[200:203]
    v_lshl_add_u32 v23, s88, 3, v22
    v_mfma_f32_16x16x32_bf16 v[204:207], v[56:59], v[236:239], v[204:207]
    s_nop 0
    v_cvt_pk_bf16_f32 v176, v176, v180
    v_cvt_pk_bf16_f32 v177, v177, v181
    v_cvt_pk_bf16_f32 v178, v178, v182
    v_cvt_pk_bf16_f32 v179, v179, v183
    v_mfma_f32_16x16x32_bf16 v[192:195], v[60:63], v[240:243], v[192:195]
    v_cvt_pk_bf16_f32 v184, v184, v188
    v_cvt_pk_bf16_f32 v185, v185, v189
    v_mfma_f32_16x16x32_bf16 v[196:199], v[60:63], v[244:247], v[196:199]
    v_cvt_pk_bf16_f32 v186, v186, v190
    v_cvt_pk_bf16_f32 v187, v187, v191
    v_mfma_f32_16x16x32_bf16 v[200:203], v[60:63], v[248:251], v[200:203]
    v_cndmask_b32_dpp v180, v177, v176, vcc row_ror:8 row_mask:0xf bank_mask:0xf
    v_cndmask_b32_dpp v181, v185, v184, vcc row_ror:8 row_mask:0xf bank_mask:0xf
    v_mfma_f32_16x16x32_bf16 v[204:207], v[60:63], v[252:255], v[204:207]
    s_not_b64 vcc, vcc
    v_cndmask_b32_dpp v182, v176, v177, vcc row_ror:8 row_mask:0xf bank_mask:0xf
    v_cndmask_b32_dpp v183, v184, v185, vcc row_ror:8 row_mask:0xf bank_mask:0xf
    buffer_store_dwordx4 v[180:183], v23, s[24:27], 0 offen sc1
    v_cndmask_b32_dpp v190, v178, v179, vcc row_ror:8 row_mask:0xf bank_mask:0xf
    v_cndmask_b32_dpp v191, v186, v187, vcc row_ror:8 row_mask:0xf bank_mask:0xf
    s_not_b64 vcc, vcc
    v_cndmask_b32_dpp v188, v179, v178, vcc row_ror:8 row_mask:0xf bank_mask:0xf
    v_cndmask_b32_dpp v189, v187, v186, vcc row_ror:8 row_mask:0xf bank_mask:0xf
    buffer_store_dwordx4 v[188:191], v23, s[24:27], s73 offen sc1
    v_cvt_pk_bf16_f32 v192, v192, v196
    v_cvt_pk_bf16_f32 v193, v193, v197
    v_cvt_pk_bf16_f32 v194, v194, v198
    v_cvt_pk_bf16_f32 v195, v195, v199
    v_cvt_pk_bf16_f32 v200, v200, v204
    v_cvt_pk_bf16_f32 v201, v201, v205
    v_cvt_pk_bf16_f32 v202, v202, v206
    v_cvt_pk_bf16_f32 v203, v203, v207
    v_cndmask_b32_dpp v196, v193, v192, vcc row_ror:8 row_mask:0xf bank_mask:0xf
    v_cndmask_b32_dpp v197, v201, v200, vcc row_ror:8 row_mask:0xf bank_mask:0xf
    s_not_b64 vcc, vcc
    v_cndmask_b32_dpp v198, v192, v193, vcc row_ror:8 row_mask:0xf bank_mask:0xf
    v_cndmask_b32_dpp v199, v200, v201, vcc row_ror:8 row_mask:0xf bank_mask:0xf
    buffer_store_dwordx4 v[196:199], v23, s[24:27], s74 offen sc1
    v_cndmask_b32_dpp v206, v194, v195, vcc row_ror:8 row_mask:0xf bank_mask:0xf
    v_cndmask_b32_dpp v207, v202, v203, vcc row_ror:8 row_mask:0xf bank_mask:0xf
    s_not_b64 vcc, vcc
    v_cndmask_b32_dpp v204, v195, v194, vcc row_ror:8 row_mask:0xf bank_mask:0xf
    v_cndmask_b32_dpp v205, v203, v202, vcc row_ror:8 row_mask:0xf bank_mask:0xf
    buffer_store_dwordx4 v[204:207], v23, s[24:27], s75 offen sc1
.if (.-L_pathL) != 15248
.error "size model mismatch"
.endif
    s_endpgm
    .p2align 12
L_pathF:
    s_mul_i32 s36, s31, 1
    s_mul_i32 s33, s36, 256
    s_lshr_b32 s33, s33, 10
    s_mul_i32 s33, s33, 4
    s_sub_u32 s36, s36, s33
    s_mul_i32 s36, s36, 36864
    s_add_u32 s45, s32, 221184
    s_add_u32 s44, s32, 368640
    s_add_u32 s36, s36, s45
    s_add_u32 s33, s30, 4
    s_sub_u32 s39, s33, 7
    s_cselect_b32 s33, s33, s39
    s_mul_i32 s33, s33, 331776
    s_add_u32 s33, s33, 294912
    s_cmp_eq_u32 s4, 6
    s_cselect_b32 s5, 2322432, s33
    s_add_u32 s6, s32, 331776
    s_cmp_eq_u32 s36, s6
    s_cselect_b32 s53, s5, s36
    s_add_u32 s36, s36, 36864
    s_cmp_eq_u32 s36, s44
    s_cselect_b32 s36, s45, s36
    s_cmp_eq_u32 s36, s6
    s_cselect_b32 s58, s5, s36
    s_sub_u32 s58, s58, 1024
    s_add_u32 s36, s36, 36864
    s_cmp_eq_u32 s36, s44
    s_cselect_b32 s36, s45, s36
    s_cmp_eq_u32 s36, s6
    s_cselect_b32 s54, s5, s36
    s_add_u32 s36, s36, 36864
    s_cmp_eq_u32 s36, s44
    s_cselect_b32 s36, s45, s36
    s_cmp_eq_u32 s36, s6
    s_cselect_b32 s59, s5, s36
    s_sub_u32 s59, s59, 1024
    s_add_u32 s33, s55, 1024
    s_cmp_eq_u32 s42, 0
    s_cselect_b32 s85, s50, s33
    s_add_u32 s33, s56, 1024
    s_cmp_eq_u32 s42, 0
    s_cselect_b32 s86, s51, s33
    s_add_u32 s33, s57, 1024
    s_cmp_eq_u32 s42, 0
    s_cselect_b32 s87, s52, s33
    s_add_u32 s33, s58, 1024
    s_cmp_eq_u32 s42, 0
    s_cselect_b32 s88, s53, s33
    s_add_u32 s33, s59, 1024
    s_cmp_eq_u32 s42, 0
    s_cselect_b32 s89, s54, s33
    s_mov_b32 s7, 5
    s_mov_b64 exec, 0
    s_cmp_eq_u32 s40, 0
    s_cbranch_scc1 L_tF0
    s_cmp_eq_u32 s40, 1
    s_cbranch_scc1 L_tF1
    s_cmp_eq_u32 s40, 2
    s_cbranch_scc1 L_tF2
    s_cmp_eq_u32 s40, 3
    s_cbranch_scc1 L_tF3
L_retF:
    s_mov_b64 exec, -1
    s_waitcnt vmcnt(11)
    v_lshlrev_b32_e32 v40, 16, v26
    v_lshlrev_b32_e32 v44, 16, v28
    v_mul_f32_e64 v34, -v44, v40
    v_mul_f32_e32 v30, s37, v40
    v_and_b32_e32 v41, s38, v26
    v_and_b32_e32 v45, s38, v28
    v_mul_f32_e64 v35, -v45, v41
    v_mul_f32_e32 v31, s37, v41
    v_lshlrev_b32_e32 v42, 16, v27
    v_lshlrev_b32_e32 v46, 16, v29
    v_mul_f32_e64 v36, -v46, v42
    v_mul_f32_e32 v32, s37, v42
    v_and_b32_e32 v43, s38, v27
    v_and_b32_e32 v47, s38, v29
    v_mul_f32_e64 v37, -v47, v43
    v_mul_f32_e32 v33, s37, v43
    s_waitcnt vmcnt(9)
    buffer_load_dwordx4 v11, s[8:11], s56 offen offset:1024 lds
    s_add_u32 m0, s43, 16384
    s_nop 0
    buffer_load_dwordx4 v11, s[8:11], s52 offen lds
    v_or3_b32 v24, v24, v176, v180
    v_fma_mix_f32 v176, v176, v30, v34 op_sel_hi:[1,0,0]
    v_fma_mix_f32 v180, v180, v30, v34 op_sel_hi:[1,0,0]
    v_or3_b32 v25, v25, v177, v181
    v_fma_mix_f32 v177, v177, v31, v35 op_sel_hi:[1,0,0]
    v_fma_mix_f32 v181, v181, v31, v35 op_sel_hi:[1,0,0]
    v_or3_b32 v24, v24, v178, v182
    v_fma_mix_f32 v178, v178, v32, v36 op_sel_hi:[1,0,0]
    v_fma_mix_f32 v182, v182, v32, v36 op_sel_hi:[1,0,0]
    v_or3_b32 v25, v25, v179, v183
    v_fma_mix_f32 v179, v179, v33, v37 op_sel_hi:[1,0,0]
    v_fma_mix_f32 v183, v183, v33, v37 op_sel_hi:[1,0,0]
    v_cvt_pk_bf16_f32 v64, v176, v180
    v_cvt_pk_bf16_f32 v68, v177, v181
    v_cvt_pk_bf16_f32 v72, v178, v182
    v_cvt_pk_bf16_f32 v76, v179, v183
    s_waitcnt vmcnt(9)
    buffer_load_dwordx4 v11, s[8:11], s57 offen offset:1024 lds
    s_add_u32 m0, s43, 24576
    v_add_u32_e32 v11, 128, v10
    buffer_load_dwordx4 v11, s[8:11], s50 offen lds
    v_or3_b32 v24, v24, v184, v188
    v_fma_mix_f32 v184, v184, v30, v34 op_sel_hi:[1,0,0]
    v_fma_mix_f32 v188, v188, v30, v34 op_sel_hi:[1,0,0]
    v_or3_b32 v25, v25, v185, v189
    v_fma_mix_f32 v185, v185, v31, v35 op_sel_hi:[1,0,0]
    v_fma_mix_f32 v189, v189, v31, v35 op_sel_hi:[1,0,0]
    v_or3_b32 v24, v24, v186, v190
    v_fma_mix_f32 v186, v186, v32, v36 op_sel_hi:[1,0,0]
    v_fma_mix_f32 v190, v190, v32, v36 op_sel_hi:[1,0,0]
    v_or3_b32 v25, v25, v187, v191
    v_fma_mix_f32 v187, v187, v33, v37 op_sel_hi:[1,0,0]
    v_fma_mix_f32 v191, v191, v33, v37 op_sel_hi:[1,0,0]
    v_cvt_pk_bf16_f32 v65, v184, v188
    v_cvt_pk_bf16_f32 v69, v185, v189
    v_cvt_pk_bf16_f32 v73, v186, v190
    v_cvt_pk_bf16_f32 v77, v187, v191
    s_waitcnt vmcnt(9)
    buffer_load_dwordx4 v11, s[8:11], s55 offen offset:1024 lds
    v_add_u32_e32 v8, 1179648, v9
    buffer_load_dwordx4 v[208:211], v8, s[12:15], s60 offen
    v_or3_b32 v24, v24, v192, v196
    v_fma_mix_f32 v192, v192, v30, v34 op_sel_hi:[1,0,0]
    v_fma_mix_f32 v196, v196, v30, v34 op_sel_hi:[1,0,0]
    v_or3_b32 v25, v25, v193, v197
    v_fma_mix_f32 v193, v193, v31, v35 op_sel_hi:[1,0,0]
    v_fma_mix_f32 v197, v197, v31, v35 op_sel_hi:[1,0,0]
    v_or3_b32 v24, v24, v194, v198
    v_fma_mix_f32 v194, v194, v32, v36 op_sel_hi:[1,0,0]
    v_fma_mix_f32 v198, v198, v32, v36 op_sel_hi:[1,0,0]
    v_or3_b32 v25, v25, v195, v199
    v_fma_mix_f32 v195, v195, v33, v37 op_sel_hi:[1,0,0]
    v_fma_mix_f32 v199, v199, v33, v37 op_sel_hi:[1,0,0]
    v_cvt_pk_bf16_f32 v66, v192, v196
    v_cvt_pk_bf16_f32 v70, v193, v197
    v_cvt_pk_bf16_f32 v74, v194, v198
    v_cvt_pk_bf16_f32 v78, v195, v199
    s_waitcnt vmcnt(9)
    buffer_load_dwordx4 v[212:215], v8, s[12:15], s61 offen
    buffer_load_dwordx4 v[216:219], v8, s[12:15], s62 offen
    v_or3_b32 v24, v24, v200, v204
    v_fma_mix_f32 v200, v200, v30, v34 op_sel_hi:[1,0,0]
    v_fma_mix_f32 v204, v204, v30, v34 op_sel_hi:[1,0,0]
    v_cvt_pk_bf16_f32 v67, v200, v204
    ds_write_b128 v20, v[64:67] offset:0
    v_or3_b32 v25, v25, v201, v205
    v_fma_mix_f32 v201, v201, v31, v35 op_sel_hi:[1,0,0]
    v_fma_mix_f32 v205, v205, v31, v35 op_sel_hi:[1,0,0]
    v_cvt_pk_bf16_f32 v71, v201, v205
    ds_write_b128 v20, v[68:71] offset:1024
    v_or3_b32 v24, v24, v202, v206
    v_fma_mix_f32 v202, v202, v32, v36 op_sel_hi:[1,0,0]
    v_fma_mix_f32 v206, v206, v32, v36 op_sel_hi:[1,0,0]
    v_cvt_pk_bf16_f32 v75, v202, v206
    ds_write_b128 v20, v[72:75] offset:2048
    v_or3_b32 v25, v25, v203, v207
    v_fma_mix_f32 v203, v203, v33, v37 op_sel_hi:[1,0,0]
    v_fma_mix_f32 v207, v207, v33, v37 op_sel_hi:[1,0,0]
    v_cvt_pk_bf16_f32 v79, v203, v207
    ds_write_b128 v20, v[76:79] offset:3072
    buffer_load_dwordx4 v[220:223], v8, s[12:15], s63 offen
    v_mul_f32_e32 v3, s68, v44
    v_rndne_f32_e32 v7, v3
    v_cmp_neq_f32_e32 vcc, v3, v7
    s_or_b64 s[46:47], s[46:47], vcc
    v_cmp_nle_f32_e64 vcc, |v44|, s69
    s_or_b64 s[46:47], s[46:47], vcc
    v_and_b32_e32 v3, s71, v44
    v_add_u32_e32 v3, -1, v3
    buffer_load_dwordx4 v[224:227], v8, s[12:15], s64 offen
    v_cmp_gt_u32_e32 vcc, s70, v3
    s_or_b64 s[46:47], s[46:47], vcc
    v_and_b32_e32 v3, s71, v40
    v_cmp_le_u32_e32 vcc, s72, v3
    s_or_b64 s[46:47], s[46:47], vcc
    v_add_u32_e32 v3, -1, v3
    v_cmp_gt_u32_e32 vcc, s70, v3
    s_or_b64 s[46:47], s[46:47], vcc
    buffer_load_dwordx4 v[228:231], v8, s[12:15], s65 offen
    v_mul_f32_e32 v3, s68, v45
    v_rndne_f32_e32 v7, v3
    v_cmp_neq_f32_e32 vcc, v3, v7
    s_or_b64 s[46:47], s[46:47], vcc
    v_cmp_nle_f32_e64 vcc, |v45|, s69
    s_or_b64 s[46:47], s[46:47], vcc
    v_and_b32_e32 v3, s71, v45
    v_add_u32_e32 v3, -1, v3
    buffer_load_dwordx4 v[232:235], v8, s[12:15], s66 offen
    v_cmp_gt_u32_e32 vcc, s70, v3
    s_or_b64 s[46:47], s[46:47], vcc
    v_and_b32_e32 v3, s71, v41
    v_cmp_le_u32_e32 vcc, s72, v3
    s_or_b64 s[46:47], s[46:47], vcc
    v_add_u32_e32 v3, -1, v3
    v_cmp_gt_u32_e32 vcc, s70, v3
    s_or_b64 s[46:47], s[46:47], vcc
    buffer_load_dwordx4 v[236:239], v8, s[12:15], s67 offen
    v_mul_f32_e32 v3, s68, v46
    s_add_u32 m0, s43, 32768
    v_rndne_f32_e32 v7, v3
    v_cmp_neq_f32_e32 vcc, v3, v7
    s_or_b64 s[46:47], s[46:47], vcc
    v_cmp_nle_f32_e64 vcc, |v46|, s69
    s_or_b64 s[46:47], s[46:47], vcc
    v_and_b32_e32 v3, s71, v46
    buffer_load_dwordx4 v11, s[8:11], s51 offen lds
    v_add_u32_e32 v3, -1, v3
    v_cmp_gt_u32_e32 vcc, s70, v3
    s_or_b64 s[46:47], s[46:47], vcc
    v_and_b32_e32 v3, s71, v42
    v_cmp_le_u32_e32 vcc, s72, v3
    s_or_b64 s[46:47], s[46:47], vcc
    v_add_u32_e32 v3, -1, v3
    v_cmp_gt_u32_e32 vcc, s70, v3
    buffer_load_dwordx4 v11, s[8:11], s56 offen offset:1024 lds
    s_or_b64 s[46:47], s[46:47], vcc
    s_add_u32 m0, s43, 40960
    v_mul_f32_e32 v3, s68, v47
    v_rndne_f32_e32 v7, v3
    v_cmp_neq_f32_e32 vcc, v3, v7
    s_or_b64 s[46:47], s[46:47], vcc
    v_cmp_nle_f32_e64 vcc, |v47|, s69
    s_or_b64 s[46:47], s[46:47], vcc
    buffer_load_dwordx4 v11, s[8:11], s52 offen lds
    v_and_b32_e32 v3, s71, v47
    v_add_u32_e32 v3, -1, v3
    v_cmp_gt_u32_e32 vcc, s70, v3
    s_or_b64 s[46:47], s[46:47], vcc
    v_and_b32_e32 v3, s71, v43
    v_cmp_le_u32_e32 vcc, s72, v3
    s_or_b64 s[46:47], s[46:47], vcc
    v_add_u32_e32 v3, -1, v3
    v_cmp_gt_u32_e32 vcc, s70, v3
    s_or_b64 s[46:47], s[46:47], vcc
    s_waitcnt vmcnt(11) lgkmcnt(0)
    s_barrier
    ds_read_b128 a[0:3], v21 offset:0
    ds_read_b128 v[40:43], v12 offset:0
    s_waitcnt vmcnt(9)
    v_or3_b32 v24, v24, v208, v212
    v_fma_mix_f32 v208, v208, v30, v34 op_sel_hi:[1,0,0]
    v_fma_mix_f32 v212, v212, v30, v34 op_sel_hi:[1,0,0]
    v_or3_b32 v25, v25, v209, v213
    ds_read_b128 a[4:7], v21 offset:1024
    ds_read_b128 v[44:47], v12 offset:4096
    v_fma_mix_f32 v209, v209, v31, v35 op_sel_hi:[1,0,0]
    v_fma_mix_f32 v213, v213, v31, v35 op_sel_hi:[1,0,0]
    v_or3_b32 v24, v24, v210, v214
    v_fma_mix_f32 v210, v210, v32, v36 op_sel_hi:[1,0,0]
    v_fma_mix_f32 v214, v214, v32, v36 op_sel_hi:[1,0,0]
    ds_read_b128 a[8:11], v21 offset:2048
    ds_read_b128 v[48:51], v13 offset:0
    v_or3_b32 v25, v25, v211, v215
    v_fma_mix_f32 v211, v211, v33, v37 op_sel_hi:[1,0,0]
    v_fma_mix_f32 v215, v215, v33, v37 op_sel_hi:[1,0,0]
    v_cvt_pk_bf16_f32 v64, v208, v212
    v_cvt_pk_bf16_f32 v68, v209, v213
    ds_read_b128 a[12:15], v21 offset:3072
    ds_read_b128 v[52:55], v13 offset:4096
    buffer_load_dwordx4 v11, s[8:11], s57 offen offset:1024 lds
    v_cvt_pk_bf16_f32 v72, v210, v214
    v_cvt_pk_bf16_f32 v76, v211, v215
    s_waitcnt vmcnt(8)
    v_or3_b32 v24, v24, v216, v220
    ds_read_b128 a[16:19], v21 offset:4096
    ds_read_b128 v[56:59], v12 offset:8192
    v_fma_mix_f32 v216, v216, v30, v34 op_sel_hi:[1,0,0]
    v_fma_mix_f32 v220, v220, v30, v34 op_sel_hi:[1,0,0]
    s_add_u32 m0, s43, 49152
    v_add_u32_e32 v11, 256, v10
    ds_read_b128 a[20:23], v21 offset:5120
    ds_read_b128 v[60:63], v12 offset:12288
    buffer_load_dwordx4 v11, s[8:11], s50 offen lds
    v_or3_b32 v25, v25, v217, v221
    v_fma_mix_f32 v217, v217, v31, v35 op_sel_hi:[1,0,0]
    v_fma_mix_f32 v221, v221, v31, v35 op_sel_hi:[1,0,0]
    s_waitcnt lgkmcnt(6)
    ds_read_b128 a[24:27], v21 offset:6144
    buffer_load_dwordx4 v11, s[8:11], s55 offen offset:1024 lds
    v_mfma_f32_16x16x32_bf16 v[80:83], v[40:43], a[0:3], 0
    v_or3_b32 v24, v24, v218, v222
    v_fma_mix_f32 v218, v218, v32, v36 op_sel_hi:[1,0,0]
    v_mfma_f32_16x16x32_bf16 v[84:87], v[40:43], a[4:7], 0
    v_add_u32_e32 v8, 2359296, v9
    s_waitcnt lgkmcnt(5)
    v_mfma_f32_16x16x32_bf16 v[88:91], v[40:43], a[8:11], 0
    ds_read_b128 a[28:31], v21 offset:7168
    v_mfma_f32_16x16x32_bf16 v[92:95], v[40:43], a[12:15], 0
    ds_read_b128 v[40:43], v13 offset:8192
    buffer_load_dwordx4 v[240:243], v8, s[12:15], s60 offen
    v_fma_mix_f32 v222, v222, v32, v36 op_sel_hi:[1,0,0]
    v_or3_b32 v25, v25, v219, v223
    v_fma_mix_f32 v219, v219, v33, v37 op_sel_hi:[1,0,0]
    v_mfma_f32_16x16x32_bf16 v[96:99], v[44:47], a[0:3], 0
    buffer_load_dwordx4 v[244:247], v8, s[12:15], s61 offen
    v_fma_mix_f32 v223, v223, v33, v37 op_sel_hi:[1,0,0]
    v_mfma_f32_16x16x32_bf16 v[100:103], v[44:47], a[4:7], 0
    v_cvt_pk_bf16_f32 v65, v216, v220
    v_cvt_pk_bf16_f32 v69, v217, v221
    v_mfma_f32_16x16x32_bf16 v[104:107], v[44:47], a[8:11], 0
    v_cvt_pk_bf16_f32 v73, v218, v222
    v_cvt_pk_bf16_f32 v77, v219, v223
    v_mfma_f32_16x16x32_bf16 v[108:111], v[44:47], a[12:15], 0
    ds_read_b128 v[44:47], v13 offset:12288
    buffer_load_dwordx4 v[248:251], v8, s[12:15], s62 offen
    s_waitcnt vmcnt(11)
    v_or3_b32 v24, v24, v224, v228
    v_fma_mix_f32 v224, v224, v30, v34 op_sel_hi:[1,0,0]
    s_waitcnt lgkmcnt(3)
    v_mfma_f32_16x16x32_bf16 v[80:83], v[48:51], a[16:19], v[80:83]
    buffer_load_dwordx4 v[252:255], v8, s[12:15], s63 offen
    v_fma_mix_f32 v228, v228, v30, v34 op_sel_hi:[1,0,0]
    v_mfma_f32_16x16x32_bf16 v[84:87], v[48:51], a[20:23], v[84:87]
    s_waitcnt vmcnt(10)
    v_or3_b32 v24, v24, v232, v236
    v_fma_mix_f32 v232, v232, v30, v34 op_sel_hi:[1,0,0]
    s_waitcnt lgkmcnt(1)
    v_mfma_f32_16x16x32_bf16 v[88:91], v[48:51], a[24:27], v[88:91]
    v_mfma_f32_16x16x32_bf16 v[92:95], v[48:51], a[28:31], v[92:95]
    ds_read_b128 v[48:51], v12 offset:16384
    buffer_load_dwordx4 v[176:179], v8, s[12:15], s64 offen
    v_fma_mix_f32 v236, v236, v30, v34 op_sel_hi:[1,0,0]
    v_cvt_pk_bf16_f32 v66, v224, v228
    v_cvt_pk_bf16_f32 v67, v232, v236
    v_or3_b32 v25, v25, v225, v229
    v_mfma_f32_16x16x32_bf16 v[96:99], v[52:55], a[16:19], v[96:99]
    ds_write_b128 v20, v[64:67] offset:16384
    v_fma_mix_f32 v225, v225, v31, v35 op_sel_hi:[1,0,0]
    v_mfma_f32_16x16x32_bf16 v[100:103], v[52:55], a[20:23], v[100:103]
    v_fma_mix_f32 v229, v229, v31, v35 op_sel_hi:[1,0,0]
    v_or3_b32 v25, v25, v233, v237
    v_mfma_f32_16x16x32_bf16 v[104:107], v[52:55], a[24:27], v[104:107]
    buffer_load_dwordx4 v[180:183], v8, s[12:15], s65 offen
    v_fma_mix_f32 v233, v233, v31, v35 op_sel_hi:[1,0,0]
    v_mfma_f32_16x16x32_bf16 v[108:111], v[52:55], a[28:31], v[108:111]
    v_fma_mix_f32 v237, v237, v31, v35 op_sel_hi:[1,0,0]
    v_cvt_pk_bf16_f32 v70, v225, v229
    v_cvt_pk_bf16_f32 v71, v233, v237
    v_mfma_f32_16x16x32_bf16 v[112:115], v[56:59], a[0:3], 0
    v_or3_b32 v24, v24, v226, v230
    ds_read_b128 v[52:55], v12 offset:20480
    v_mfma_f32_16x16x32_bf16 v[116:119], v[56:59], a[4:7], 0
    buffer_load_dwordx4 v[184:187], v8, s[12:15], s66 offen
    v_fma_mix_f32 v226, v226, v32, v36 op_sel_hi:[1,0,0]
    v_mfma_f32_16x16x32_bf16 v[120:123], v[56:59], a[8:11], 0
    v_fma_mix_f32 v230, v230, v32, v36 op_sel_hi:[1,0,0]
    v_or3_b32 v24, v24, v234, v238
    v_mfma_f32_16x16x32_bf16 v[124:127], v[56:59], a[12:15], 0
    ds_write_b128 v20, v[68:71] offset:17408
    v_fma_mix_f32 v234, v234, v32, v36 op_sel_hi:[1,0,0]
    v_mfma_f32_16x16x32_bf16 v[128:131], v[60:63], a[0:3], 0
    v_fma_mix_f32 v238, v238, v32, v36 op_sel_hi:[1,0,0]
    v_cvt_pk_bf16_f32 v74, v226, v230
    v_mfma_f32_16x16x32_bf16 v[132:135], v[60:63], a[4:7], 0
    buffer_load_dwordx4 v[188:191], v8, s[12:15], s67 offen
    s_add_u32 m0, s43, 57344
    v_mfma_f32_16x16x32_bf16 v[136:139], v[60:63], a[8:11], 0
    v_cvt_pk_bf16_f32 v75, v234, v238
    ds_read_b128 v[56:59], v13 offset:16384
    v_mfma_f32_16x16x32_bf16 v[140:143], v[60:63], a[12:15], 0
    ds_read_b128 v[60:63], v13 offset:20480
    buffer_load_dwordx4 v11, s[8:11], s51 offen lds
    v_or3_b32 v25, v25, v227, v231
    v_fma_mix_f32 v227, v227, v33, v37 op_sel_hi:[1,0,0]
    v_fma_mix_f32 v231, v231, v33, v37 op_sel_hi:[1,0,0]
    v_mfma_f32_16x16x32_bf16 v[112:115], v[40:43], a[16:19], v[112:115]
    ds_write_b128 v20, v[72:75] offset:18432
    v_or3_b32 v25, v25, v235, v239
    v_mfma_f32_16x16x32_bf16 v[116:119], v[40:43], a[20:23], v[116:119]
    v_fma_mix_f32 v235, v235, v33, v37 op_sel_hi:[1,0,0]
    v_fma_mix_f32 v239, v239, v33, v37 op_sel_hi:[1,0,0]
    v_mfma_f32_16x16x32_bf16 v[120:123], v[40:43], a[24:27], v[120:123]
    buffer_load_dwordx4 v11, s[8:11], s56 offen offset:1024 lds
    s_add_u32 m0, s43, 65536
    v_mfma_f32_16x16x32_bf16 v[124:127], v[40:43], a[28:31], v[124:127]
    v_cvt_pk_bf16_f32 v78, v227, v231
    v_cvt_pk_bf16_f32 v79, v235, v239
    s_waitcnt vmcnt(8) lgkmcnt(3)
    v_mfma_f32_16x16x32_bf16 v[128:131], v[44:47], a[16:19], v[128:131]
    ds_read_b128 v[40:43], v12 offset:24576
    buffer_load_dwordx4 v11, s[8:11], s52 offen lds
    v_mfma_f32_16x16x32_bf16 v[132:135], v[44:47], a[20:23], v[132:135]
    v_or3_b32 v24, v24, v240, v244
    v_fma_mix_f32 v240, v240, v30, v34 op_sel_hi:[1,0,0]
    v_fma_mix_f32 v244, v244, v30, v34 op_sel_hi:[1,0,0]
    v_or3_b32 v25, v25, v241, v245
    v_mfma_f32_16x16x32_bf16 v[136:139], v[44:47], a[24:27], v[136:139]
    ds_write_b128 v20, v[76:79] offset:19456
    v_fma_mix_f32 v241, v241, v31, v35 op_sel_hi:[1,0,0]
    v_mfma_f32_16x16x32_bf16 v[140:143], v[44:47], a[28:31], v[140:143]
    v_fma_mix_f32 v245, v245, v31, v35 op_sel_hi:[1,0,0]
    v_or3_b32 v24, v24, v242, v246
    v_mfma_f32_16x16x32_bf16 v[144:147], v[48:51], a[0:3], 0
    buffer_load_dwordx4 v11, s[8:11], s57 offen offset:1024 lds
    v_fma_mix_f32 v242, v242, v32, v36 op_sel_hi:[1,0,0]
    v_mfma_f32_16x16x32_bf16 v[148:151], v[48:51], a[4:7], 0
    v_fma_mix_f32 v246, v246, v32, v36 op_sel_hi:[1,0,0]
    s_add_u32 m0, s43, 73728
    v_add_u32_e32 v11, 384, v10
    v_mfma_f32_16x16x32_bf16 v[152:155], v[48:51], a[8:11], 0
    v_or3_b32 v25, v25, v243, v247
    ds_read_b128 v[44:47], v12 offset:28672
    v_mfma_f32_16x16x32_bf16 v[156:159], v[48:51], a[12:15], 0
    ds_read_b128 v[48:51], v13 offset:24576
    buffer_load_dwordx4 v11, s[8:11], s50 offen lds
    v_fma_mix_f32 v243, v243, v33, v37 op_sel_hi:[1,0,0]
    v_mfma_f32_16x16x32_bf16 v[160:163], v[52:55], a[0:3], 0
    v_fma_mix_f32 v247, v247, v33, v37 op_sel_hi:[1,0,0]
    v_cvt_pk_bf16_f32 v64, v240, v244
    v_mfma_f32_16x16x32_bf16 v[164:167], v[52:55], a[4:7], 0
    s_waitcnt lgkmcnt(2)
    s_barrier
    v_mfma_f32_16x16x32_bf16 v[168:171], v[52:55], a[8:11], 0
    ds_read_b128 a[32:35], v21 offset:16384
    v_mfma_f32_16x16x32_bf16 v[172:175], v[52:55], a[12:15], 0
    ds_read_b128 v[52:55], v13 offset:28672
    buffer_load_dwordx4 v11, s[8:11], s55 offen offset:1024 lds
    v_cvt_pk_bf16_f32 v68, v241, v245
    v_cvt_pk_bf16_f32 v72, v242, v246
    v_add_u32_e32 v8, 3538944, v9
    v_mfma_f32_16x16x32_bf16 v[144:147], v[56:59], a[16:19], v[144:147]
    ds_read_b128 a[36:39], v21 offset:17408
    buffer_load_dwordx4 v[192:195], v8, s[12:15], s60 offen
    v_mfma_f32_16x16x32_bf16 v[148:151], v[56:59], a[20:23], v[148:151]
    v_cvt_pk_bf16_f32 v76, v243, v247
    s_waitcnt vmcnt(11)
    v_or3_b32 v24, v24, v248, v252
    v_mfma_f32_16x16x32_bf16 v[152:155], v[56:59], a[24:27], v[152:155]
    v_fma_mix_f32 v248, v248, v30, v34 op_sel_hi:[1,0,0]
    ds_read_b128 a[40:43], v21 offset:18432
    v_mfma_f32_16x16x32_bf16 v[156:159], v[56:59], a[28:31], v[156:159]
    ds_read_b128 v[56:59], v12 offset:32768
    v_fma_mix_f32 v252, v252, v30, v34 op_sel_hi:[1,0,0]
    v_or3_b32 v25, v25, v249, v253
    v_fma_mix_f32 v249, v249, v31, v35 op_sel_hi:[1,0,0]
    v_fma_mix_f32 v253, v253, v31, v35 op_sel_hi:[1,0,0]
    v_mfma_f32_16x16x32_bf16 v[160:163], v[60:63], a[16:19], v[160:163]
    ds_read_b128 a[44:47], v21 offset:19456
    buffer_load_dwordx4 v[196:199], v8, s[12:15], s61 offen
    v_mfma_f32_16x16x32_bf16 v[164:167], v[60:63], a[20:23], v[164:167]
    v_or3_b32 v24, v24, v250, v254
    v_fma_mix_f32 v250, v250, v32, v36 op_sel_hi:[1,0,0]
    v_mfma_f32_16x16x32_bf16 v[168:171], v[60:63], a[24:27], v[168:171]
    v_fma_mix_f32 v254, v254, v32, v36 op_sel_hi:[1,0,0]
    ds_read_b128 a[48:51], v21 offset:20480
    v_mfma_f32_16x16x32_bf16 v[172:175], v[60:63], a[28:31], v[172:175]
    ds_read_b128 v[60:63], v12 offset:36864
    v_or3_b32 v25, v25, v251, v255
    v_fma_mix_f32 v251, v251, v33, v37 op_sel_hi:[1,0,0]
    s_waitcnt lgkmcnt(5)
    v_mfma_f32_16x16x32_bf16 v[80:83], v[40:43], a[32:35], v[80:83]
    ds_read_b128 a[52:55], v21 offset:21504
    buffer_load_dwordx4 v[200:203], v8, s[12:15], s62 offen
    v_mfma_f32_16x16x32_bf16 v[84:87], v[40:43], a[36:39], v[84:87]
    v_fma_mix_f32 v255, v255, v33, v37 op_sel_hi:[1,0,0]
    v_cvt_pk_bf16_f32 v65, v248, v252
    s_waitcnt lgkmcnt(3)
    v_mfma_f32_16x16x32_bf16 v[88:91], v[40:43], a[40:43], v[88:91]
    ds_read_b128 a[56:59], v21 offset:22528
    v_mfma_f32_16x16x32_bf16 v[92:95], v[40:43], a[44:47], v[92:95]
    ds_read_b128 v[40:43], v13 offset:32768
    v_cvt_pk_bf16_f32 v69, v249, v253
    v_cvt_pk_bf16_f32 v73, v250, v254
    v_cvt_pk_bf16_f32 v77, v251, v255
    v_mfma_f32_16x16x32_bf16 v[96:99], v[44:47], a[32:35], v[96:99]
    ds_read_b128 a[60:63], v21 offset:23552
    buffer_load_dwordx4 v[204:207], v8, s[12:15], s63 offen
    v_mfma_f32_16x16x32_bf16 v[100:103], v[44:47], a[36:39], v[100:103]
    s_waitcnt vmcnt(12)
    v_or3_b32 v24, v24, v176, v180
    v_mfma_f32_16x16x32_bf16 v[104:107], v[44:47], a[40:43], v[104:107]
    v_fma_mix_f32 v176, v176, v30, v34 op_sel_hi:[1,0,0]
    v_fma_mix_f32 v180, v180, v30, v34 op_sel_hi:[1,0,0]
    v_mfma_f32_16x16x32_bf16 v[108:111], v[44:47], a[44:47], v[108:111]
    ds_read_b128 v[44:47], v13 offset:36864
    buffer_load_dwordx4 v[208:211], v8, s[12:15], s64 offen
    s_waitcnt vmcnt(11)
    v_or3_b32 v24, v24, v184, v188
    v_fma_mix_f32 v184, v184, v30, v34 op_sel_hi:[1,0,0]
    s_waitcnt lgkmcnt(4)
    v_mfma_f32_16x16x32_bf16 v[80:83], v[48:51], a[48:51], v[80:83]
    v_fma_mix_f32 v188, v188, v30, v34 op_sel_hi:[1,0,0]
    v_cvt_pk_bf16_f32 v66, v176, v180
    v_mfma_f32_16x16x32_bf16 v[84:87], v[48:51], a[52:55], v[84:87]
    v_cvt_pk_bf16_f32 v67, v184, v188
    v_or3_b32 v25, v25, v177, v181
    s_waitcnt lgkmcnt(1)
    v_mfma_f32_16x16x32_bf16 v[88:91], v[48:51], a[56:59], v[88:91]
    v_mfma_f32_16x16x32_bf16 v[92:95], v[48:51], a[60:63], v[92:95]
    ds_read_b128 v[48:51], v12 offset:40960
    buffer_load_dwordx4 v[212:215], v8, s[12:15], s65 offen
    v_fma_mix_f32 v177, v177, v31, v35 op_sel_hi:[1,0,0]
    v_fma_mix_f32 v181, v181, v31, v35 op_sel_hi:[1,0,0]
    v_mfma_f32_16x16x32_bf16 v[96:99], v[52:55], a[48:51], v[96:99]
    v_or3_b32 v25, v25, v185, v189
    v_fma_mix_f32 v185, v185, v31, v35 op_sel_hi:[1,0,0]
    v_mfma_f32_16x16x32_bf16 v[100:103], v[52:55], a[52:55], v[100:103]
    ds_write_b128 v20, v[64:67] offset:0
    v_mfma_f32_16x16x32_bf16 v[104:107], v[52:55], a[56:59], v[104:107]
    v_fma_mix_f32 v189, v189, v31, v35 op_sel_hi:[1,0,0]
    v_cvt_pk_bf16_f32 v70, v177, v181
    v_mfma_f32_16x16x32_bf16 v[108:111], v[52:55], a[60:63], v[108:111]
    v_cvt_pk_bf16_f32 v71, v185, v189
    buffer_load_dwordx4 v[216:219], v8, s[12:15], s66 offen
    v_mfma_f32_16x16x32_bf16 v[112:115], v[56:59], a[32:35], v[112:115]
    v_or3_b32 v24, v24, v178, v182
    ds_read_b128 v[52:55], v12 offset:45056
    v_mfma_f32_16x16x32_bf16 v[116:119], v[56:59], a[36:39], v[116:119]
    v_fma_mix_f32 v178, v178, v32, v36 op_sel_hi:[1,0,0]
    v_fma_mix_f32 v182, v182, v32, v36 op_sel_hi:[1,0,0]
    v_mfma_f32_16x16x32_bf16 v[120:123], v[56:59], a[40:43], v[120:123]
    v_or3_b32 v24, v24, v186, v190
    v_fma_mix_f32 v186, v186, v32, v36 op_sel_hi:[1,0,0]
    v_mfma_f32_16x16x32_bf16 v[124:127], v[56:59], a[44:47], v[124:127]
    ds_write_b128 v20, v[68:71] offset:1024
    v_fma_mix_f32 v190, v190, v32, v36 op_sel_hi:[1,0,0]
    v_mfma_f32_16x16x32_bf16 v[128:131], v[60:63], a[32:35], v[128:131]
    v_cvt_pk_bf16_f32 v74, v178, v182
    v_cvt_pk_bf16_f32 v75, v186, v190
    v_mfma_f32_16x16x32_bf16 v[132:135], v[60:63], a[36:39], v[132:135]
    buffer_load_dwordx4 v[220:223], v8, s[12:15], s67 offen
    s_add_u32 m0, s43, 81920
    v_mfma_f32_16x16x32_bf16 v[136:139], v[60:63], a[40:43], v[136:139]
    v_or3_b32 v25, v25, v179, v183
    ds_read_b128 v[56:59], v13 offset:40960
    v_mfma_f32_16x16x32_bf16 v[140:143], v[60:63], a[44:47], v[140:143]
    ds_read_b128 v[60:63], v13 offset:45056
    buffer_load_dwordx4 v11, s[8:11], s51 offen lds
    v_fma_mix_f32 v179, v179, v33, v37 op_sel_hi:[1,0,0]
    v_fma_mix_f32 v183, v183, v33, v37 op_sel_hi:[1,0,0]
    v_or3_b32 v25, v25, v187, v191
    v_mfma_f32_16x16x32_bf16 v[112:115], v[40:43], a[48:51], v[112:115]
    ds_write_b128 v20, v[72:75] offset:2048
    v_fma_mix_f32 v187, v187, v33, v37 op_sel_hi:[1,0,0]
    v_mfma_f32_16x16x32_bf16 v[116:119], v[40:43], a[52:55], v[116:119]
    v_fma_mix_f32 v191, v191, v33, v37 op_sel_hi:[1,0,0]
    v_cvt_pk_bf16_f32 v78, v179, v183
    v_mfma_f32_16x16x32_bf16 v[120:123], v[40:43], a[56:59], v[120:123]
    buffer_load_dwordx4 v11, s[8:11], s56 offen offset:1024 lds
    s_add_u32 m0, s43, 90112
    v_mfma_f32_16x16x32_bf16 v[124:127], v[40:43], a[60:63], v[124:127]
    v_cvt_pk_bf16_f32 v79, v187, v191
    s_waitcnt vmcnt(8)
    v_or3_b32 v24, v24, v192, v196
    s_waitcnt lgkmcnt(3)
    v_mfma_f32_16x16x32_bf16 v[128:131], v[44:47], a[48:51], v[128:131]
    ds_read_b128 v[40:43], v12 offset:49152
    buffer_load_dwordx4 v11, s[8:11], s52 offen lds
    v_mfma_f32_16x16x32_bf16 v[132:135], v[44:47], a[52:55], v[132:135]
    v_fma_mix_f32 v192, v192, v30, v34 op_sel_hi:[1,0,0]
    v_fma_mix_f32 v196, v196, v30, v34 op_sel_hi:[1,0,0]
    v_or3_b32 v25, v25, v193, v197
    v_fma_mix_f32 v193, v193, v31, v35 op_sel_hi:[1,0,0]
    v_mfma_f32_16x16x32_bf16 v[136:139], v[44:47], a[56:59], v[136:139]
    ds_write_b128 v20, v[76:79] offset:3072
    v_fma_mix_f32 v197, v197, v31, v35 op_sel_hi:[1,0,0]
    v_mfma_f32_16x16x32_bf16 v[140:143], v[44:47], a[60:63], v[140:143]
    v_or3_b32 v24, v24, v194, v198
    v_fma_mix_f32 v194, v194, v32, v36 op_sel_hi:[1,0,0]
    v_mfma_f32_16x16x32_bf16 v[144:147], v[48:51], a[32:35], v[144:147]
    buffer_load_dwordx4 v11, s[8:11], s57 offen offset:1024 lds
    s_add_u32 m0, s43, 98304
    v_mfma_f32_16x16x32_bf16 v[148:151], v[48:51], a[36:39], v[148:151]
    v_add_u32_e32 v11, 512, v10
    v_fma_mix_f32 v198, v198, v32, v36 op_sel_hi:[1,0,0]
    v_or3_b32 v25, v25, v195, v199
    v_mfma_f32_16x16x32_bf16 v[152:155], v[48:51], a[40:43], v[152:155]
    v_fma_mix_f32 v195, v195, v33, v37 op_sel_hi:[1,0,0]
    ds_read_b128 v[44:47], v12 offset:53248
    v_mfma_f32_16x16x32_bf16 v[156:159], v[48:51], a[44:47], v[156:159]
    ds_read_b128 v[48:51], v13 offset:49152
    buffer_load_dwordx4 v11, s[8:11], s50 offen lds
    v_fma_mix_f32 v199, v199, v33, v37 op_sel_hi:[1,0,0]
    v_mfma_f32_16x16x32_bf16 v[160:163], v[52:55], a[32:35], v[160:163]
    v_cvt_pk_bf16_f32 v64, v192, v196
    v_cvt_pk_bf16_f32 v68, v193, v197
    v_mfma_f32_16x16x32_bf16 v[164:167], v[52:55], a[36:39], v[164:167]
    s_waitcnt lgkmcnt(2)
    s_barrier
    v_mfma_f32_16x16x32_bf16 v[168:171], v[52:55], a[40:43], v[168:171]
    ds_read_b128 a[64:67], v21 offset:0
L_tF0:
    s_cbranch_execz L_retF
    v_mfma_f32_16x16x32_bf16 v[172:175], v[52:55], a[44:47], v[172:175]
    ds_read_b128 v[52:55], v13 offset:53248
    buffer_load_dwordx4 v11, s[8:11], s55 offen offset:1024 lds
    v_add_u32_e32 v8, 4718592, v9
    v_cvt_pk_bf16_f32 v72, v194, v198
    v_mfma_f32_16x16x32_bf16 v[144:147], v[56:59], a[48:51], v[144:147]
    v_cvt_pk_bf16_f32 v76, v195, v199
    ds_read_b128 a[68:71], v21 offset:1024
    v_mfma_f32_16x16x32_bf16 v[148:151], v[56:59], a[52:55], v[148:151]
    s_waitcnt vmcnt(10)
    v_or3_b32 v24, v24, v200, v204
    v_fma_mix_f32 v200, v200, v30, v34 op_sel_hi:[1,0,0]
    v_fma_mix_f32 v204, v204, v30, v34 op_sel_hi:[1,0,0]
    v_mfma_f32_16x16x32_bf16 v[152:155], v[56:59], a[56:59], v[152:155]
    v_or3_b32 v25, v25, v201, v205
    ds_read_b128 a[72:75], v21 offset:2048
    v_mfma_f32_16x16x32_bf16 v[156:159], v[56:59], a[60:63], v[156:159]
    ds_read_b128 v[56:59], v12 offset:57344
    buffer_load_dwordx4 v[224:227], v8, s[12:15], s60 offen
    v_fma_mix_f32 v201, v201, v31, v35 op_sel_hi:[1,0,0]
    v_mfma_f32_16x16x32_bf16 v[160:163], v[60:63], a[48:51], v[160:163]
    v_fma_mix_f32 v205, v205, v31, v35 op_sel_hi:[1,0,0]
    ds_read_b128 a[76:79], v21 offset:3072
    v_mfma_f32_16x16x32_bf16 v[164:167], v[60:63], a[52:55], v[164:167]
    buffer_load_dwordx4 v[228:231], v8, s[12:15], s61 offen
    v_or3_b32 v24, v24, v202, v206
    v_mfma_f32_16x16x32_bf16 v[168:171], v[60:63], a[56:59], v[168:171]
    v_fma_mix_f32 v202, v202, v32, v36 op_sel_hi:[1,0,0]
    ds_read_b128 a[80:83], v21 offset:4096
    v_mfma_f32_16x16x32_bf16 v[172:175], v[60:63], a[60:63], v[172:175]
    ds_read_b128 v[60:63], v12 offset:61440
    v_fma_mix_f32 v206, v206, v32, v36 op_sel_hi:[1,0,0]
    v_or3_b32 v25, v25, v203, v207
    v_fma_mix_f32 v203, v203, v33, v37 op_sel_hi:[1,0,0]
    s_waitcnt lgkmcnt(5)
    v_mfma_f32_16x16x32_bf16 v[80:83], v[40:43], a[64:67], v[80:83]
    ds_read_b128 a[84:87], v21 offset:5120
    buffer_load_dwordx4 v[232:235], v8, s[12:15], s62 offen
    v_mfma_f32_16x16x32_bf16 v[84:87], v[40:43], a[68:71], v[84:87]
    v_fma_mix_f32 v207, v207, v33, v37 op_sel_hi:[1,0,0]
    v_cvt_pk_bf16_f32 v65, v200, v204
    s_waitcnt lgkmcnt(3)
    v_mfma_f32_16x16x32_bf16 v[88:91], v[40:43], a[72:75], v[88:91]
    ds_read_b128 a[88:91], v21 offset:6144
    v_mfma_f32_16x16x32_bf16 v[92:95], v[40:43], a[76:79], v[92:95]
    ds_read_b128 v[40:43], v13 offset:57344
    v_cvt_pk_bf16_f32 v69, v201, v205
    v_cvt_pk_bf16_f32 v73, v202, v206
    v_cvt_pk_bf16_f32 v77, v203, v207
    s_waitcnt vmcnt(11)
    v_mfma_f32_16x16x32_bf16 v[96:99], v[44:47], a[64:67], v[96:99]
    ds_read_b128 a[92:95], v21 offset:7168
    buffer_load_dwordx4 v[236:239], v8, s[12:15], s63 offen
    v_mfma_f32_16x16x32_bf16 v[100:103], v[44:47], a[68:71], v[100:103]
    v_or3_b32 v24, v24, v208, v212
    v_fma_mix_f32 v208, v208, v30, v34 op_sel_hi:[1,0,0]
    v_mfma_f32_16x16x32_bf16 v[104:107], v[44:47], a[72:75], v[104:107]
    v_fma_mix_f32 v212, v212, v30, v34 op_sel_hi:[1,0,0]
    s_waitcnt vmcnt(10)
    v_mfma_f32_16x16x32_bf16 v[108:111], v[44:47], a[76:79], v[108:111]
    ds_read_b128 v[44:47], v13 offset:61440
    buffer_load_dwordx4 v[240:243], v8, s[12:15], s64 offen
    v_or3_b32 v24, v24, v216, v220
    v_fma_mix_f32 v216, v216, v30, v34 op_sel_hi:[1,0,0]
    v_fma_mix_f32 v220, v220, v30, v34 op_sel_hi:[1,0,0]
    s_waitcnt lgkmcnt(4)
    v_mfma_f32_16x16x32_bf16 v[80:83], v[48:51], a[80:83], v[80:83]
    v_cvt_pk_bf16_f32 v66, v208, v212
    v_cvt_pk_bf16_f32 v67, v216, v220
    v_mfma_f32_16x16x32_bf16 v[84:87], v[48:51], a[84:87], v[84:87]
    v_or3_b32 v25, v25, v209, v213
    s_waitcnt lgkmcnt(1)
    v_mfma_f32_16x16x32_bf16 v[88:91], v[48:51], a[88:91], v[88:91]
    v_mfma_f32_16x16x32_bf16 v[92:95], v[48:51], a[92:95], v[92:95]
    ds_read_b128 v[48:51], v14 offset:0
    buffer_load_dwordx4 v[244:247], v8, s[12:15], s65 offen
    v_fma_mix_f32 v209, v209, v31, v35 op_sel_hi:[1,0,0]
    v_fma_mix_f32 v213, v213, v31, v35 op_sel_hi:[1,0,0]
    v_or3_b32 v25, v25, v217, v221
    v_mfma_f32_16x16x32_bf16 v[96:99], v[52:55], a[80:83], v[96:99]
    ds_write_b128 v20, v[64:67] offset:16384
    v_mfma_f32_16x16x32_bf16 v[100:103], v[52:55], a[84:87], v[100:103]
    v_fma_mix_f32 v217, v217, v31, v35 op_sel_hi:[1,0,0]
    v_fma_mix_f32 v221, v221, v31, v35 op_sel_hi:[1,0,0]
    v_mfma_f32_16x16x32_bf16 v[104:107], v[52:55], a[88:91], v[104:107]
    v_cvt_pk_bf16_f32 v70, v209, v213
    buffer_load_dwordx4 v[248:251], v8, s[12:15], s66 offen
    v_mfma_f32_16x16x32_bf16 v[108:111], v[52:55], a[92:95], v[108:111]
    v_cvt_pk_bf16_f32 v71, v217, v221
    ds_read_b128 v[52:55], v14 offset:4096
    v_mfma_f32_16x16x32_bf16 v[112:115], v[56:59], a[64:67], v[112:115]
    v_or3_b32 v24, v24, v210, v214
    v_fma_mix_f32 v210, v210, v32, v36 op_sel_hi:[1,0,0]
    v_mfma_f32_16x16x32_bf16 v[116:119], v[56:59], a[68:71], v[116:119]
    v_fma_mix_f32 v214, v214, v32, v36 op_sel_hi:[1,0,0]
    v_or3_b32 v24, v24, v218, v222
    v_mfma_f32_16x16x32_bf16 v[120:123], v[56:59], a[72:75], v[120:123]
    ds_write_b128 v20, v[68:71] offset:17408
    v_mfma_f32_16x16x32_bf16 v[124:127], v[56:59], a[76:79], v[124:127]
    v_fma_mix_f32 v218, v218, v32, v36 op_sel_hi:[1,0,0]
    v_fma_mix_f32 v222, v222, v32, v36 op_sel_hi:[1,0,0]
    v_mfma_f32_16x16x32_bf16 v[128:131], v[60:63], a[64:67], v[128:131]
    v_cvt_pk_bf16_f32 v74, v210, v214
    buffer_load_dwordx4 v[252:255], v8, s[12:15], s67 offen
    v_mfma_f32_16x16x32_bf16 v[132:135], v[60:63], a[68:71], v[132:135]
    s_add_u32 m0, s43, 106496
    v_cvt_pk_bf16_f32 v75, v218, v222
    v_mfma_f32_16x16x32_bf16 v[136:139], v[60:63], a[72:75], v[136:139]
    v_or3_b32 v25, v25, v211, v215
    ds_read_b128 v[56:59], v15 offset:0
    v_mfma_f32_16x16x32_bf16 v[140:143], v[60:63], a[76:79], v[140:143]
    ds_read_b128 v[60:63], v15 offset:4096
    buffer_load_dwordx4 v11, s[8:11], s51 offen lds
    v_fma_mix_f32 v211, v211, v33, v37 op_sel_hi:[1,0,0]
    v_fma_mix_f32 v215, v215, v33, v37 op_sel_hi:[1,0,0]
    v_or3_b32 v25, v25, v219, v223
    v_mfma_f32_16x16x32_bf16 v[112:115], v[40:43], a[80:83], v[112:115]
    ds_write_b128 v20, v[72:75] offset:18432
    v_fma_mix_f32 v219, v219, v33, v37 op_sel_hi:[1,0,0]
    v_mfma_f32_16x16x32_bf16 v[116:119], v[40:43], a[84:87], v[116:119]
    v_fma_mix_f32 v223, v223, v33, v37 op_sel_hi:[1,0,0]
    v_cvt_pk_bf16_f32 v78, v211, v215
    v_mfma_f32_16x16x32_bf16 v[120:123], v[40:43], a[88:91], v[120:123]
    buffer_load_dwordx4 v11, s[8:11], s56 offen offset:1024 lds
    s_add_u32 m0, s43, 114688
    v_mfma_f32_16x16x32_bf16 v[124:127], v[40:43], a[92:95], v[124:127]
    v_cvt_pk_bf16_f32 v79, v219, v223
    s_waitcnt vmcnt(8)
    v_or3_b32 v24, v24, v224, v228
    s_waitcnt lgkmcnt(3)
    v_mfma_f32_16x16x32_bf16 v[128:131], v[44:47], a[80:83], v[128:131]
    ds_read_b128 v[40:43], v14 offset:8192
    buffer_load_dwordx4 v11, s[8:11], s52 offen lds
    v_mfma_f32_16x16x32_bf16 v[132:135], v[44:47], a[84:87], v[132:135]
    v_fma_mix_f32 v224, v224, v30, v34 op_sel_hi:[1,0,0]
    v_fma_mix_f32 v228, v228, v30, v34 op_sel_hi:[1,0,0]
    v_or3_b32 v25, v25, v225, v229
    v_fma_mix_f32 v225, v225, v31, v35 op_sel_hi:[1,0,0]
    v_mfma_f32_16x16x32_bf16 v[136:139], v[44:47], a[88:91], v[136:139]
    ds_write_b128 v20, v[76:79] offset:19456
    v_fma_mix_f32 v229, v229, v31, v35 op_sel_hi:[1,0,0]
    v_mfma_f32_16x16x32_bf16 v[140:143], v[44:47], a[92:95], v[140:143]
    v_or3_b32 v24, v24, v226, v230
    v_fma_mix_f32 v226, v226, v32, v36 op_sel_hi:[1,0,0]
    v_mfma_f32_16x16x32_bf16 v[144:147], v[48:51], a[64:67], v[144:147]
    buffer_load_dwordx4 v11, s[8:11], s57 offen offset:1024 lds
    v_fma_mix_f32 v230, v230, v32, v36 op_sel_hi:[1,0,0]
    v_mfma_f32_16x16x32_bf16 v[148:151], v[48:51], a[68:71], v[148:151]
    v_or3_b32 v25, v25, v227, v231
    s_add_u32 m0, s43, 122880
    v_add_u32_e32 v11, 640, v10
    v_mfma_f32_16x16x32_bf16 v[152:155], v[48:51], a[72:75], v[152:155]
    v_fma_mix_f32 v227, v227, v33, v37 op_sel_hi:[1,0,0]
    ds_read_b128 v[44:47], v14 offset:12288
    v_mfma_f32_16x16x32_bf16 v[156:159], v[48:51], a[76:79], v[156:159]
    ds_read_b128 v[48:51], v15 offset:8192
    buffer_load_dwordx4 v11, s[8:11], s50 offen lds
    v_fma_mix_f32 v231, v231, v33, v37 op_sel_hi:[1,0,0]
    v_mfma_f32_16x16x32_bf16 v[160:163], v[52:55], a[64:67], v[160:163]
    v_cvt_pk_bf16_f32 v64, v224, v228
    v_cvt_pk_bf16_f32 v68, v225, v229
    v_mfma_f32_16x16x32_bf16 v[164:167], v[52:55], a[68:71], v[164:167]
    s_waitcnt lgkmcnt(2)
    s_barrier
    v_mfma_f32_16x16x32_bf16 v[168:171], v[52:55], a[72:75], v[168:171]
    ds_read_b128 a[96:99], v21 offset:16384
    v_mfma_f32_16x16x32_bf16 v[172:175], v[52:55], a[76:79], v[172:175]
    ds_read_b128 v[52:55], v15 offset:12288
    buffer_load_dwordx4 v11, s[8:11], s55 offen offset:1024 lds
    v_cvt_pk_bf16_f32 v72, v226, v230
    v_add_u32_e32 v8, 5898240, v9
    v_mfma_f32_16x16x32_bf16 v[144:147], v[56:59], a[80:83], v[144:147]
    v_cvt_pk_bf16_f32 v76, v227, v231
    ds_read_b128 a[100:103], v21 offset:17408
    v_mfma_f32_16x16x32_bf16 v[148:151], v[56:59], a[84:87], v[148:151]
    s_waitcnt vmcnt(10)
    v_or3_b32 v24, v24, v232, v236
    v_fma_mix_f32 v232, v232, v30, v34 op_sel_hi:[1,0,0]
    v_fma_mix_f32 v236, v236, v30, v34 op_sel_hi:[1,0,0]
    v_mfma_f32_16x16x32_bf16 v[152:155], v[56:59], a[88:91], v[152:155]
    v_or3_b32 v25, v25, v233, v237
    ds_read_b128 a[104:107], v21 offset:18432
    v_mfma_f32_16x16x32_bf16 v[156:159], v[56:59], a[92:95], v[156:159]
    ds_read_b128 v[56:59], v14 offset:16384
    buffer_load_dwordx4 v[176:179], v8, s[12:15], s60 offen
    v_fma_mix_f32 v233, v233, v31, v35 op_sel_hi:[1,0,0]
    v_fma_mix_f32 v237, v237, v31, v35 op_sel_hi:[1,0,0]
    v_or3_b32 v24, v24, v234, v238
    v_mfma_f32_16x16x32_bf16 v[160:163], v[60:63], a[80:83], v[160:163]
    ds_read_b128 a[108:111], v21 offset:19456
    buffer_load_dwordx4 v[180:183], v8, s[12:15], s61 offen
    v_mfma_f32_16x16x32_bf16 v[164:167], v[60:63], a[84:87], v[164:167]
    v_fma_mix_f32 v234, v234, v32, v36 op_sel_hi:[1,0,0]
    v_fma_mix_f32 v238, v238, v32, v36 op_sel_hi:[1,0,0]
    v_mfma_f32_16x16x32_bf16 v[168:171], v[60:63], a[88:91], v[168:171]
    v_or3_b32 v25, v25, v235, v239
    ds_read_b128 a[112:115], v21 offset:20480
    v_mfma_f32_16x16x32_bf16 v[172:175], v[60:63], a[92:95], v[172:175]
    ds_read_b128 v[60:63], v14 offset:20480
    v_fma_mix_f32 v235, v235, v33, v37 op_sel_hi:[1,0,0]
    v_fma_mix_f32 v239, v239, v33, v37 op_sel_hi:[1,0,0]
    s_waitcnt lgkmcnt(5)
    v_mfma_f32_16x16x32_bf16 v[80:83], v[40:43], a[96:99], v[80:83]
    ds_read_b128 a[116:119], v21 offset:21504
    buffer_load_dwordx4 v[184:187], v8, s[12:15], s62 offen
    v_mfma_f32_16x16x32_bf16 v[84:87], v[40:43], a[100:103], v[84:87]
    v_cvt_pk_bf16_f32 v65, v232, v236
    v_cvt_pk_bf16_f32 v69, v233, v237
    s_waitcnt lgkmcnt(3)
    v_mfma_f32_16x16x32_bf16 v[88:91], v[40:43], a[104:107], v[88:91]
    ds_read_b128 a[120:123], v21 offset:22528
    v_mfma_f32_16x16x32_bf16 v[92:95], v[40:43], a[108:111], v[92:95]
    ds_read_b128 v[40:43], v15 offset:16384
    v_cvt_pk_bf16_f32 v73, v234, v238
    v_cvt_pk_bf16_f32 v77, v235, v239
    s_waitcnt vmcnt(11)
    v_or3_b32 v24, v24, v240, v244
    v_mfma_f32_16x16x32_bf16 v[96:99], v[44:47], a[96:99], v[96:99]
    ds_read_b128 a[124:127], v21 offset:23552
    buffer_load_dwordx4 v[188:191], v8, s[12:15], s63 offen
    v_mfma_f32_16x16x32_bf16 v[100:103], v[44:47], a[100:103], v[100:103]
    v_fma_mix_f32 v240, v240, v30, v34 op_sel_hi:[1,0,0]
    v_fma_mix_f32 v244, v244, v30, v34 op_sel_hi:[1,0,0]
    v_mfma_f32_16x16x32_bf16 v[104:107], v[44:47], a[104:107], v[104:107]
    s_waitcnt vmcnt(10)
    v_or3_b32 v24, v24, v248, v252
    v_mfma_f32_16x16x32_bf16 v[108:111], v[44:47], a[108:111], v[108:111]
    ds_read_b128 v[44:47], v15 offset:20480
    buffer_load_dwordx4 v[192:195], v8, s[12:15], s64 offen
    v_fma_mix_f32 v248, v248, v30, v34 op_sel_hi:[1,0,0]
    v_fma_mix_f32 v252, v252, v30, v34 op_sel_hi:[1,0,0]
    v_cvt_pk_bf16_f32 v66, v240, v244
    s_waitcnt lgkmcnt(4)
    v_mfma_f32_16x16x32_bf16 v[80:83], v[48:51], a[112:115], v[80:83]
    v_cvt_pk_bf16_f32 v67, v248, v252
    v_or3_b32 v25, v25, v241, v245
    v_mfma_f32_16x16x32_bf16 v[84:87], v[48:51], a[116:119], v[84:87]
    s_waitcnt lgkmcnt(1)
    v_mfma_f32_16x16x32_bf16 v[88:91], v[48:51], a[120:123], v[88:91]
    v_mfma_f32_16x16x32_bf16 v[92:95], v[48:51], a[124:127], v[92:95]
    ds_read_b128 v[48:51], v14 offset:24576
    buffer_load_dwordx4 v[196:199], v8, s[12:15], s65 offen
    v_fma_mix_f32 v241, v241, v31, v35 op_sel_hi:[1,0,0]
    v_fma_mix_f32 v245, v245, v31, v35 op_sel_hi:[1,0,0]
    v_mfma_f32_16x16x32_bf16 v[96:99], v[52:55], a[112:115], v[96:99]
    v_or3_b32 v25, v25, v249, v253
    v_fma_mix_f32 v249, v249, v31, v35 op_sel_hi:[1,0,0]
    v_mfma_f32_16x16x32_bf16 v[100:103], v[52:55], a[116:119], v[100:103]
    ds_write_b128 v20, v[64:67] offset:0
    v_fma_mix_f32 v253, v253, v31, v35 op_sel_hi:[1,0,0]
    v_mfma_f32_16x16x32_bf16 v[104:107], v[52:55], a[120:123], v[104:107]
    v_cvt_pk_bf16_f32 v70, v241, v245
    v_cvt_pk_bf16_f32 v71, v249, v253
    v_mfma_f32_16x16x32_bf16 v[108:111], v[52:55], a[124:127], v[108:111]
    buffer_load_dwordx4 v[200:203], v8, s[12:15], s66 offen
    v_or3_b32 v24, v24, v242, v246
    v_mfma_f32_16x16x32_bf16 v[112:115], v[56:59], a[96:99], v[112:115]
    ds_read_b128 v[52:55], v14 offset:28672
    buffer_load_dwordx4 v[204:207], v8, s[12:15], s67 offen
    v_mfma_f32_16x16x32_bf16 v[116:119], v[56:59], a[100:103], v[116:119]
    s_add_u32 m0, s43, 0
    v_fma_mix_f32 v242, v242, v32, v36 op_sel_hi:[1,0,0]
    v_mfma_f32_16x16x32_bf16 v[120:123], v[56:59], a[104:107], v[120:123]
    v_fma_mix_f32 v246, v246, v32, v36 op_sel_hi:[1,0,0]
    v_or3_b32 v24, v24, v250, v254
    v_mfma_f32_16x16x32_bf16 v[124:127], v[56:59], a[108:111], v[124:127]
    ds_write_b128 v20, v[68:71] offset:1024
    v_fma_mix_f32 v250, v250, v32, v36 op_sel_hi:[1,0,0]
    v_mfma_f32_16x16x32_bf16 v[128:131], v[60:63], a[96:99], v[128:131]
    v_fma_mix_f32 v254, v254, v32, v36 op_sel_hi:[1,0,0]
    v_cvt_pk_bf16_f32 v74, v242, v246
    v_mfma_f32_16x16x32_bf16 v[132:135], v[60:63], a[100:103], v[132:135]
    buffer_load_dwordx4 v11, s[8:11], s51 offen lds
    v_cvt_pk_bf16_f32 v75, v250, v254
    v_mfma_f32_16x16x32_bf16 v[136:139], v[60:63], a[104:107], v[136:139]
    v_or3_b32 v25, v25, v243, v247
    ds_read_b128 v[56:59], v15 offset:24576
    v_mfma_f32_16x16x32_bf16 v[140:143], v[60:63], a[108:111], v[140:143]
    ds_read_b128 v[60:63], v15 offset:28672
    v_fma_mix_f32 v243, v243, v33, v37 op_sel_hi:[1,0,0]
    v_fma_mix_f32 v247, v247, v33, v37 op_sel_hi:[1,0,0]
    v_or3_b32 v25, v25, v251, v255
    v_mfma_f32_16x16x32_bf16 v[112:115], v[40:43], a[112:115], v[112:115]
    ds_write_b128 v20, v[72:75] offset:2048
    v_fma_mix_f32 v251, v251, v33, v37 op_sel_hi:[1,0,0]
    v_mfma_f32_16x16x32_bf16 v[116:119], v[40:43], a[116:119], v[116:119]
    v_fma_mix_f32 v255, v255, v33, v37 op_sel_hi:[1,0,0]
    v_cvt_pk_bf16_f32 v78, v243, v247
    v_mfma_f32_16x16x32_bf16 v[120:123], v[40:43], a[120:123], v[120:123]
    buffer_load_dwordx4 v11, s[8:11], s56 offen offset:1024 lds
    s_add_u32 m0, s43, 8192
    v_mfma_f32_16x16x32_bf16 v[124:127], v[40:43], a[124:127], v[124:127]
    v_cvt_pk_bf16_f32 v79, v251, v255
    s_waitcnt vmcnt(8)
    v_or3_b32 v24, v24, v176, v180
    s_waitcnt lgkmcnt(3)
    v_mfma_f32_16x16x32_bf16 v[128:131], v[44:47], a[112:115], v[128:131]
    ds_read_b128 v[40:43], v14 offset:32768
    buffer_load_dwordx4 v11, s[8:11], s52 offen lds
    v_mfma_f32_16x16x32_bf16 v[132:135], v[44:47], a[116:119], v[132:135]
    v_fma_mix_f32 v176, v176, v30, v34 op_sel_hi:[1,0,0]
    v_fma_mix_f32 v180, v180, v30, v34 op_sel_hi:[1,0,0]
    v_or3_b32 v25, v25, v177, v181
    v_fma_mix_f32 v177, v177, v31, v35 op_sel_hi:[1,0,0]
    v_mfma_f32_16x16x32_bf16 v[136:139], v[44:47], a[120:123], v[136:139]
    ds_write_b128 v20, v[76:79] offset:3072
    v_fma_mix_f32 v181, v181, v31, v35 op_sel_hi:[1,0,0]
    v_mfma_f32_16x16x32_bf16 v[140:143], v[44:47], a[124:127], v[140:143]
    v_or3_b32 v24, v24, v178, v182
    v_fma_mix_f32 v178, v178, v32, v36 op_sel_hi:[1,0,0]
    v_mfma_f32_16x16x32_bf16 v[144:147], v[48:51], a[96:99], v[144:147]
    buffer_load_dwordx4 v11, s[8:11], s57 offen offset:1024 lds
    v_fma_mix_f32 v182, v182, v32, v36 op_sel_hi:[1,0,0]
    v_mfma_f32_16x16x32_bf16 v[148:151], v[48:51], a[100:103], v[148:151]
    s_add_u32 m0, s43, 16384
    v_add_u32_e32 v11, 768, v10
    v_or3_b32 v25, v25, v179, v183
    v_mfma_f32_16x16x32_bf16 v[152:155], v[48:51], a[104:107], v[152:155]
    v_fma_mix_f32 v179, v179, v33, v37 op_sel_hi:[1,0,0]
    ds_read_b128 v[44:47], v14 offset:36864
    v_mfma_f32_16x16x32_bf16 v[156:159], v[48:51], a[108:111], v[156:159]
    ds_read_b128 v[48:51], v15 offset:32768
    buffer_load_dwordx4 v11, s[8:11], s50 offen lds
    v_fma_mix_f32 v183, v183, v33, v37 op_sel_hi:[1,0,0]
    v_mfma_f32_16x16x32_bf16 v[160:163], v[52:55], a[96:99], v[160:163]
    v_cvt_pk_bf16_f32 v64, v176, v180
    v_cvt_pk_bf16_f32 v68, v177, v181
    v_mfma_f32_16x16x32_bf16 v[164:167], v[52:55], a[100:103], v[164:167]
    s_waitcnt lgkmcnt(2)
    s_barrier
    v_mfma_f32_16x16x32_bf16 v[168:171], v[52:55], a[104:107], v[168:171]
    ds_read_b128 a[128:131], v21 offset:0
    v_mfma_f32_16x16x32_bf16 v[172:175], v[52:55], a[108:111], v[172:175]
    ds_read_b128 v[52:55], v15 offset:36864
    buffer_load_dwordx4 v11, s[8:11], s55 offen offset:1024 lds
    v_cvt_pk_bf16_f32 v72, v178, v182
    v_add_u32_e32 v8, 7077888, v9
    v_cvt_pk_bf16_f32 v76, v179, v183
    v_mfma_f32_16x16x32_bf16 v[144:147], v[56:59], a[112:115], v[144:147]
    ds_read_b128 a[132:135], v21 offset:1024
    buffer_load_dwordx4 v[208:211], v8, s[12:15], s60 offen
    v_mfma_f32_16x16x32_bf16 v[148:151], v[56:59], a[116:119], v[148:151]
    s_waitcnt vmcnt(11)
    v_or3_b32 v24, v24, v184, v188
    v_fma_mix_f32 v184, v184, v30, v34 op_sel_hi:[1,0,0]
    v_mfma_f32_16x16x32_bf16 v[152:155], v[56:59], a[120:123], v[152:155]
    v_fma_mix_f32 v188, v188, v30, v34 op_sel_hi:[1,0,0]
    ds_read_b128 a[136:139], v21 offset:2048
    v_mfma_f32_16x16x32_bf16 v[156:159], v[56:59], a[124:127], v[156:159]
    ds_read_b128 v[56:59], v14 offset:40960
    v_or3_b32 v25, v25, v185, v189
    v_fma_mix_f32 v185, v185, v31, v35 op_sel_hi:[1,0,0]
    v_fma_mix_f32 v189, v189, v31, v35 op_sel_hi:[1,0,0]
    v_mfma_f32_16x16x32_bf16 v[160:163], v[60:63], a[112:115], v[160:163]
    v_or3_b32 v24, v24, v186, v190
    ds_read_b128 a[140:143], v21 offset:3072
    v_mfma_f32_16x16x32_bf16 v[164:167], v[60:63], a[116:119], v[164:167]
    buffer_load_dwordx4 v[212:215], v8, s[12:15], s61 offen
    v_fma_mix_f32 v186, v186, v32, v36 op_sel_hi:[1,0,0]
    v_mfma_f32_16x16x32_bf16 v[168:171], v[60:63], a[120:123], v[168:171]
    v_fma_mix_f32 v190, v190, v32, v36 op_sel_hi:[1,0,0]
    ds_read_b128 a[144:147], v21 offset:4096
    v_mfma_f32_16x16x32_bf16 v[172:175], v[60:63], a[124:127], v[172:175]
    ds_read_b128 v[60:63], v14 offset:45056
    v_or3_b32 v25, v25, v187, v191
    v_fma_mix_f32 v187, v187, v33, v37 op_sel_hi:[1,0,0]
    s_waitcnt lgkmcnt(5)
    v_mfma_f32_16x16x32_bf16 v[80:83], v[40:43], a[128:131], v[80:83]
    ds_read_b128 a[148:151], v21 offset:5120
    buffer_load_dwordx4 v[216:219], v8, s[12:15], s62 offen
    v_mfma_f32_16x16x32_bf16 v[84:87], v[40:43], a[132:135], v[84:87]
    v_fma_mix_f32 v191, v191, v33, v37 op_sel_hi:[1,0,0]
    v_cvt_pk_bf16_f32 v65, v184, v188
    s_waitcnt lgkmcnt(3)
    v_mfma_f32_16x16x32_bf16 v[88:91], v[40:43], a[136:139], v[88:91]
    ds_read_b128 a[152:155], v21 offset:6144
    v_mfma_f32_16x16x32_bf16 v[92:95], v[40:43], a[140:143], v[92:95]
    ds_read_b128 v[40:43], v15 offset:40960
    v_cvt_pk_bf16_f32 v69, v185, v189
    v_cvt_pk_bf16_f32 v73, v186, v190
    v_cvt_pk_bf16_f32 v77, v187, v191
    s_waitcnt vmcnt(11)
    v_mfma_f32_16x16x32_bf16 v[96:99], v[44:47], a[128:131], v[96:99]
    ds_read_b128 a[156:159], v21 offset:7168
    buffer_load_dwordx4 v[220:223], v8, s[12:15], s63 offen
    v_mfma_f32_16x16x32_bf16 v[100:103], v[44:47], a[132:135], v[100:103]
    v_or3_b32 v24, v24, v192, v196
    v_fma_mix_f32 v192, v192, v30, v34 op_sel_hi:[1,0,0]
    v_mfma_f32_16x16x32_bf16 v[104:107], v[44:47], a[136:139], v[104:107]
    v_fma_mix_f32 v196, v196, v30, v34 op_sel_hi:[1,0,0]
    s_waitcnt vmcnt(10)
    v_mfma_f32_16x16x32_bf16 v[108:111], v[44:47], a[140:143], v[108:111]
    ds_read_b128 v[44:47], v15 offset:45056
    buffer_load_dwordx4 v[224:227], v8, s[12:15], s64 offen
    v_or3_b32 v24, v24, v200, v204
    v_fma_mix_f32 v200, v200, v30, v34 op_sel_hi:[1,0,0]
    v_fma_mix_f32 v204, v204, v30, v34 op_sel_hi:[1,0,0]
    s_waitcnt lgkmcnt(4)
    v_mfma_f32_16x16x32_bf16 v[80:83], v[48:51], a[144:147], v[80:83]
    v_cvt_pk_bf16_f32 v66, v192, v196
    v_cvt_pk_bf16_f32 v67, v200, v204
    v_mfma_f32_16x16x32_bf16 v[84:87], v[48:51], a[148:151], v[84:87]
    s_waitcnt lgkmcnt(1)
    v_mfma_f32_16x16x32_bf16 v[88:91], v[48:51], a[152:155], v[88:91]
    v_mfma_f32_16x16x32_bf16 v[92:95], v[48:51], a[156:159], v[92:95]
    ds_read_b128 v[48:51], v14 offset:49152
    buffer_load_dwordx4 v[228:231], v8, s[12:15], s65 offen
    v_or3_b32 v25, v25, v193, v197
    v_fma_mix_f32 v193, v193, v31, v35 op_sel_hi:[1,0,0]
    v_fma_mix_f32 v197, v197, v31, v35 op_sel_hi:[1,0,0]
    v_or3_b32 v25, v25, v201, v205
    v_mfma_f32_16x16x32_bf16 v[96:99], v[52:55], a[144:147], v[96:99]
    ds_write_b128 v20, v[64:67] offset:16384
    v_mfma_f32_16x16x32_bf16 v[100:103], v[52:55], a[148:151], v[100:103]
    v_fma_mix_f32 v201, v201, v31, v35 op_sel_hi:[1,0,0]
    v_fma_mix_f32 v205, v205, v31, v35 op_sel_hi:[1,0,0]
    v_mfma_f32_16x16x32_bf16 v[104:107], v[52:55], a[152:155], v[104:107]
    v_cvt_pk_bf16_f32 v70, v193, v197
    buffer_load_dwordx4 v[232:235], v8, s[12:15], s66 offen
    v_mfma_f32_16x16x32_bf16 v[108:111], v[52:55], a[156:159], v[108:111]
    v_cvt_pk_bf16_f32 v71, v201, v205
    v_or3_b32 v24, v24, v194, v198
    v_mfma_f32_16x16x32_bf16 v[112:115], v[56:59], a[128:131], v[112:115]
    ds_read_b128 v[52:55], v14 offset:53248
    buffer_load_dwordx4 v[236:239], v8, s[12:15], s67 offen
    v_mfma_f32_16x16x32_bf16 v[116:119], v[56:59], a[132:135], v[116:119]
    s_add_u32 m0, s43, 24576
    v_fma_mix_f32 v194, v194, v32, v36 op_sel_hi:[1,0,0]
    v_mfma_f32_16x16x32_bf16 v[120:123], v[56:59], a[136:139], v[120:123]
    v_fma_mix_f32 v198, v198, v32, v36 op_sel_hi:[1,0,0]
    v_or3_b32 v24, v24, v202, v206
    v_mfma_f32_16x16x32_bf16 v[124:127], v[56:59], a[140:143], v[124:127]
    ds_write_b128 v20, v[68:71] offset:17408
    v_fma_mix_f32 v202, v202, v32, v36 op_sel_hi:[1,0,0]
    v_mfma_f32_16x16x32_bf16 v[128:131], v[60:63], a[128:131], v[128:131]
    v_fma_mix_f32 v206, v206, v32, v36 op_sel_hi:[1,0,0]
    v_cvt_pk_bf16_f32 v74, v194, v198
    v_mfma_f32_16x16x32_bf16 v[132:135], v[60:63], a[132:135], v[132:135]
    buffer_load_dwordx4 v11, s[8:11], s51 offen lds
    v_cvt_pk_bf16_f32 v75, v202, v206
    v_mfma_f32_16x16x32_bf16 v[136:139], v[60:63], a[136:139], v[136:139]
    v_or3_b32 v25, v25, v195, v199
    ds_read_b128 v[56:59], v15 offset:49152
    v_mfma_f32_16x16x32_bf16 v[140:143], v[60:63], a[140:143], v[140:143]
    ds_read_b128 v[60:63], v15 offset:53248
    v_fma_mix_f32 v195, v195, v33, v37 op_sel_hi:[1,0,0]
    v_fma_mix_f32 v199, v199, v33, v37 op_sel_hi:[1,0,0]
    v_or3_b32 v25, v25, v203, v207
    v_fma_mix_f32 v203, v203, v33, v37 op_sel_hi:[1,0,0]
    v_mfma_f32_16x16x32_bf16 v[112:115], v[40:43], a[144:147], v[112:115]
    ds_write_b128 v20, v[72:75] offset:18432
    v_fma_mix_f32 v207, v207, v33, v37 op_sel_hi:[1,0,0]
    v_mfma_f32_16x16x32_bf16 v[116:119], v[40:43], a[148:151], v[116:119]
    v_cvt_pk_bf16_f32 v78, v195, v199
    v_cvt_pk_bf16_f32 v79, v203, v207
    v_mfma_f32_16x16x32_bf16 v[120:123], v[40:43], a[152:155], v[120:123]
    buffer_load_dwordx4 v11, s[8:11], s56 offen offset:1024 lds
    s_add_u32 m0, s43, 32768
    v_mfma_f32_16x16x32_bf16 v[124:127], v[40:43], a[156:159], v[124:127]
    s_waitcnt vmcnt(8)
    v_or3_b32 v24, v24, v208, v212
    v_fma_mix_f32 v208, v208, v30, v34 op_sel_hi:[1,0,0]
    s_waitcnt lgkmcnt(3)
    v_mfma_f32_16x16x32_bf16 v[128:131], v[44:47], a[144:147], v[128:131]
    ds_read_b128 v[40:43], v14 offset:57344
    buffer_load_dwordx4 v11, s[8:11], s52 offen lds
    v_mfma_f32_16x16x32_bf16 v[132:135], v[44:47], a[148:151], v[132:135]
    v_fma_mix_f32 v212, v212, v30, v34 op_sel_hi:[1,0,0]
    v_or3_b32 v25, v25, v209, v213
    v_fma_mix_f32 v209, v209, v31, v35 op_sel_hi:[1,0,0]
    v_fma_mix_f32 v213, v213, v31, v35 op_sel_hi:[1,0,0]
    v_mfma_f32_16x16x32_bf16 v[136:139], v[44:47], a[152:155], v[136:139]
    ds_write_b128 v20, v[76:79] offset:19456
    v_or3_b32 v24, v24, v210, v214
    v_mfma_f32_16x16x32_bf16 v[140:143], v[44:47], a[156:159], v[140:143]
    v_fma_mix_f32 v210, v210, v32, v36 op_sel_hi:[1,0,0]
    v_fma_mix_f32 v214, v214, v32, v36 op_sel_hi:[1,0,0]
    v_mfma_f32_16x16x32_bf16 v[144:147], v[48:51], a[128:131], v[144:147]
    buffer_load_dwordx4 v11, s[8:11], s57 offen offset:1024 lds
    s_add_u32 m0, s43, 40960
    v_mfma_f32_16x16x32_bf16 v[148:151], v[48:51], a[132:135], v[148:151]
    v_add_u32_e32 v11, 896, v10
    v_or3_b32 v25, v25, v211, v215
    v_fma_mix_f32 v211, v211, v33, v37 op_sel_hi:[1,0,0]
    v_mfma_f32_16x16x32_bf16 v[152:155], v[48:51], a[136:139], v[152:155]
    v_fma_mix_f32 v215, v215, v33, v37 op_sel_hi:[1,0,0]
    ds_read_b128 v[44:47], v14 offset:61440
    v_mfma_f32_16x16x32_bf16 v[156:159], v[48:51], a[140:143], v[156:159]
    ds_read_b128 v[48:51], v15 offset:57344
    buffer_load_dwordx4 v11, s[8:11], s50 offen lds
    v_mfma_f32_16x16x32_bf16 v[160:163], v[52:55], a[128:131], v[160:163]
    v_cvt_pk_bf16_f32 v64, v208, v212
    v_cvt_pk_bf16_f32 v68, v209, v213
    v_mfma_f32_16x16x32_bf16 v[164:167], v[52:55], a[132:135], v[164:167]
    s_waitcnt lgkmcnt(2)
    s_barrier
    v_mfma_f32_16x16x32_bf16 v[168:171], v[52:55], a[136:139], v[168:171]
    ds_read_b128 a[160:163], v21 offset:16384
    v_mfma_f32_16x16x32_bf16 v[172:175], v[52:55], a[140:143], v[172:175]
    ds_read_b128 v[52:55], v15 offset:61440
    buffer_load_dwordx4 v11, s[8:11], s55 offen offset:1024 lds
    v_add_u32_e32 v8, 8257536, v9
    v_cvt_pk_bf16_f32 v72, v210, v214
    v_cvt_pk_bf16_f32 v76, v211, v215
    v_mfma_f32_16x16x32_bf16 v[144:147], v[56:59], a[144:147], v[144:147]
    ds_read_b128 a[164:167], v21 offset:17408
    buffer_load_dwordx4 v[240:243], v8, s[12:15], s60 offen
    v_mfma_f32_16x16x32_bf16 v[148:151], v[56:59], a[148:151], v[148:151]
    s_waitcnt vmcnt(11)
    v_or3_b32 v24, v24, v216, v220
    v_fma_mix_f32 v216, v216, v30, v34 op_sel_hi:[1,0,0]
    v_mfma_f32_16x16x32_bf16 v[152:155], v[56:59], a[152:155], v[152:155]
    v_fma_mix_f32 v220, v220, v30, v34 op_sel_hi:[1,0,0]
    ds_read_b128 a[168:171], v21 offset:18432
    v_mfma_f32_16x16x32_bf16 v[156:159], v[56:59], a[156:159], v[156:159]
    ds_read_b128 v[56:59], v12 offset:0
    v_or3_b32 v25, v25, v217, v221
    v_fma_mix_f32 v217, v217, v31, v35 op_sel_hi:[1,0,0]
    v_fma_mix_f32 v221, v221, v31, v35 op_sel_hi:[1,0,0]
    v_mfma_f32_16x16x32_bf16 v[160:163], v[60:63], a[144:147], v[160:163]
    v_or3_b32 v24, v24, v218, v222
    ds_read_b128 a[172:175], v21 offset:19456
    v_mfma_f32_16x16x32_bf16 v[164:167], v[60:63], a[148:151], v[164:167]
    buffer_load_dwordx4 v[244:247], v8, s[12:15], s61 offen
    v_fma_mix_f32 v218, v218, v32, v36 op_sel_hi:[1,0,0]
    v_mfma_f32_16x16x32_bf16 v[168:171], v[60:63], a[152:155], v[168:171]
    v_fma_mix_f32 v222, v222, v32, v36 op_sel_hi:[1,0,0]
    ds_read_b128 a[176:179], v21 offset:20480
    v_mfma_f32_16x16x32_bf16 v[172:175], v[60:63], a[156:159], v[172:175]
L_tF1:
    s_cbranch_execz L_retF
    ds_read_b128 v[60:63], v12 offset:4096
    v_or3_b32 v25, v25, v219, v223
    v_fma_mix_f32 v219, v219, v33, v37 op_sel_hi:[1,0,0]
    s_waitcnt lgkmcnt(5)
    v_mfma_f32_16x16x32_bf16 v[80:83], v[40:43], a[160:163], v[80:83]
    ds_read_b128 a[180:183], v21 offset:21504
    buffer_load_dwordx4 v[248:251], v8, s[12:15], s62 offen
    v_mfma_f32_16x16x32_bf16 v[84:87], v[40:43], a[164:167], v[84:87]
    v_fma_mix_f32 v223, v223, v33, v37 op_sel_hi:[1,0,0]
    v_cvt_pk_bf16_f32 v65, v216, v220
    s_waitcnt lgkmcnt(3)
    v_mfma_f32_16x16x32_bf16 v[88:91], v[40:43], a[168:171], v[88:91]
    ds_read_b128 a[184:187], v21 offset:22528
    v_mfma_f32_16x16x32_bf16 v[92:95], v[40:43], a[172:175], v[92:95]
    ds_read_b128 v[40:43], v13 offset:0
    v_cvt_pk_bf16_f32 v69, v217, v221
    v_cvt_pk_bf16_f32 v73, v218, v222
    v_cvt_pk_bf16_f32 v77, v219, v223
    s_waitcnt vmcnt(11)
    v_mfma_f32_16x16x32_bf16 v[96:99], v[44:47], a[160:163], v[96:99]
    ds_read_b128 a[188:191], v21 offset:23552
    buffer_load_dwordx4 v[252:255], v8, s[12:15], s63 offen
    v_mfma_f32_16x16x32_bf16 v[100:103], v[44:47], a[164:167], v[100:103]
    v_or3_b32 v24, v24, v224, v228
    v_fma_mix_f32 v224, v224, v30, v34 op_sel_hi:[1,0,0]
    v_mfma_f32_16x16x32_bf16 v[104:107], v[44:47], a[168:171], v[104:107]
    v_fma_mix_f32 v228, v228, v30, v34 op_sel_hi:[1,0,0]
    s_waitcnt vmcnt(10)
    v_mfma_f32_16x16x32_bf16 v[108:111], v[44:47], a[172:175], v[108:111]
    ds_read_b128 v[44:47], v13 offset:4096
    buffer_load_dwordx4 v[176:179], v8, s[12:15], s64 offen
    v_or3_b32 v24, v24, v232, v236
    v_fma_mix_f32 v232, v232, v30, v34 op_sel_hi:[1,0,0]
    v_fma_mix_f32 v236, v236, v30, v34 op_sel_hi:[1,0,0]
    s_waitcnt lgkmcnt(4)
    v_mfma_f32_16x16x32_bf16 v[80:83], v[48:51], a[176:179], v[80:83]
    v_cvt_pk_bf16_f32 v66, v224, v228
    v_cvt_pk_bf16_f32 v67, v232, v236
    v_mfma_f32_16x16x32_bf16 v[84:87], v[48:51], a[180:183], v[84:87]
    v_or3_b32 v25, v25, v225, v229
    s_waitcnt lgkmcnt(1)
    v_mfma_f32_16x16x32_bf16 v[88:91], v[48:51], a[184:187], v[88:91]
    v_mfma_f32_16x16x32_bf16 v[92:95], v[48:51], a[188:191], v[92:95]
    ds_read_b128 v[48:51], v12 offset:8192
    buffer_load_dwordx4 v[180:183], v8, s[12:15], s65 offen
    v_fma_mix_f32 v225, v225, v31, v35 op_sel_hi:[1,0,0]
    v_fma_mix_f32 v229, v229, v31, v35 op_sel_hi:[1,0,0]
    v_or3_b32 v25, v25, v233, v237
    v_mfma_f32_16x16x32_bf16 v[96:99], v[52:55], a[176:179], v[96:99]
    ds_write_b128 v20, v[64:67] offset:0
    v_mfma_f32_16x16x32_bf16 v[100:103], v[52:55], a[180:183], v[100:103]
    v_fma_mix_f32 v233, v233, v31, v35 op_sel_hi:[1,0,0]
    v_fma_mix_f32 v237, v237, v31, v35 op_sel_hi:[1,0,0]
    v_mfma_f32_16x16x32_bf16 v[104:107], v[52:55], a[184:187], v[104:107]
    v_cvt_pk_bf16_f32 v70, v225, v229
    buffer_load_dwordx4 v[184:187], v8, s[12:15], s66 offen
    v_mfma_f32_16x16x32_bf16 v[108:111], v[52:55], a[188:191], v[108:111]
    v_cvt_pk_bf16_f32 v71, v233, v237
    v_or3_b32 v24, v24, v226, v230
    v_mfma_f32_16x16x32_bf16 v[112:115], v[56:59], a[160:163], v[112:115]
    ds_read_b128 v[52:55], v12 offset:12288
    buffer_load_dwordx4 v[188:191], v8, s[12:15], s67 offen
    v_mfma_f32_16x16x32_bf16 v[116:119], v[56:59], a[164:167], v[116:119]
    s_add_u32 m0, s43, 49152
    v_fma_mix_f32 v226, v226, v32, v36 op_sel_hi:[1,0,0]
    v_mfma_f32_16x16x32_bf16 v[120:123], v[56:59], a[168:171], v[120:123]
    v_fma_mix_f32 v230, v230, v32, v36 op_sel_hi:[1,0,0]
    v_or3_b32 v24, v24, v234, v238
    v_mfma_f32_16x16x32_bf16 v[124:127], v[56:59], a[172:175], v[124:127]
    ds_write_b128 v20, v[68:71] offset:1024
    v_mfma_f32_16x16x32_bf16 v[128:131], v[60:63], a[160:163], v[128:131]
    v_fma_mix_f32 v234, v234, v32, v36 op_sel_hi:[1,0,0]
    v_fma_mix_f32 v238, v238, v32, v36 op_sel_hi:[1,0,0]
    v_mfma_f32_16x16x32_bf16 v[132:135], v[60:63], a[164:167], v[132:135]
    v_cvt_pk_bf16_f32 v74, v226, v230
    buffer_load_dwordx4 v11, s[8:11], s51 offen lds
    v_mfma_f32_16x16x32_bf16 v[136:139], v[60:63], a[168:171], v[136:139]
    v_cvt_pk_bf16_f32 v75, v234, v238
    ds_read_b128 v[56:59], v13 offset:8192
    v_mfma_f32_16x16x32_bf16 v[140:143], v[60:63], a[172:175], v[140:143]
    ds_read_b128 v[60:63], v13 offset:12288
    v_or3_b32 v25, v25, v227, v231
    v_fma_mix_f32 v227, v227, v33, v37 op_sel_hi:[1,0,0]
    v_fma_mix_f32 v231, v231, v33, v37 op_sel_hi:[1,0,0]
    v_or3_b32 v25, v25, v235, v239
    v_mfma_f32_16x16x32_bf16 v[112:115], v[40:43], a[176:179], v[112:115]
    ds_write_b128 v20, v[72:75] offset:2048
    v_fma_mix_f32 v235, v235, v33, v37 op_sel_hi:[1,0,0]
    v_mfma_f32_16x16x32_bf16 v[116:119], v[40:43], a[180:183], v[116:119]
    v_fma_mix_f32 v239, v239, v33, v37 op_sel_hi:[1,0,0]
    v_cvt_pk_bf16_f32 v78, v227, v231
    v_mfma_f32_16x16x32_bf16 v[120:123], v[40:43], a[184:187], v[120:123]
    buffer_load_dwordx4 v11, s[8:11], s56 offen offset:1024 lds
    s_add_u32 m0, s43, 57344
    v_mfma_f32_16x16x32_bf16 v[124:127], v[40:43], a[188:191], v[124:127]
    v_cvt_pk_bf16_f32 v79, v235, v239
    s_waitcnt vmcnt(8)
    v_or3_b32 v24, v24, v240, v244
    s_waitcnt lgkmcnt(3)
    v_mfma_f32_16x16x32_bf16 v[128:131], v[44:47], a[176:179], v[128:131]
    ds_read_b128 v[40:43], v12 offset:16384
    buffer_load_dwordx4 v11, s[8:11], s52 offen lds
    v_mfma_f32_16x16x32_bf16 v[132:135], v[44:47], a[180:183], v[132:135]
    v_fma_mix_f32 v240, v240, v30, v34 op_sel_hi:[1,0,0]
    v_fma_mix_f32 v244, v244, v30, v34 op_sel_hi:[1,0,0]
    v_or3_b32 v25, v25, v241, v245
    v_fma_mix_f32 v241, v241, v31, v35 op_sel_hi:[1,0,0]
    v_mfma_f32_16x16x32_bf16 v[136:139], v[44:47], a[184:187], v[136:139]
    ds_write_b128 v20, v[76:79] offset:3072
    v_fma_mix_f32 v245, v245, v31, v35 op_sel_hi:[1,0,0]
    v_mfma_f32_16x16x32_bf16 v[140:143], v[44:47], a[188:191], v[140:143]
    v_or3_b32 v24, v24, v242, v246
    v_fma_mix_f32 v242, v242, v32, v36 op_sel_hi:[1,0,0]
    v_mfma_f32_16x16x32_bf16 v[144:147], v[48:51], a[160:163], v[144:147]
    buffer_load_dwordx4 v11, s[8:11], s57 offen offset:1024 lds
    v_fma_mix_f32 v246, v246, v32, v36 op_sel_hi:[1,0,0]
    v_mfma_f32_16x16x32_bf16 v[148:151], v[48:51], a[164:167], v[148:151]
    s_add_u32 m0, s43, 65536
    v_add_u32_e32 v11, 1024, v10
    v_or3_b32 v25, v25, v243, v247
    v_mfma_f32_16x16x32_bf16 v[152:155], v[48:51], a[168:171], v[152:155]
    v_fma_mix_f32 v243, v243, v33, v37 op_sel_hi:[1,0,0]
    ds_read_b128 v[44:47], v12 offset:20480
    v_mfma_f32_16x16x32_bf16 v[156:159], v[48:51], a[172:175], v[156:159]
    ds_read_b128 v[48:51], v13 offset:16384
    buffer_load_dwordx4 v11, s[8:11], s50 offen lds
    v_fma_mix_f32 v247, v247, v33, v37 op_sel_hi:[1,0,0]
    v_mfma_f32_16x16x32_bf16 v[160:163], v[52:55], a[160:163], v[160:163]
    v_cvt_pk_bf16_f32 v64, v240, v244
    v_cvt_pk_bf16_f32 v68, v241, v245
    v_mfma_f32_16x16x32_bf16 v[164:167], v[52:55], a[164:167], v[164:167]
    s_waitcnt lgkmcnt(2)
    s_barrier
    v_mfma_f32_16x16x32_bf16 v[168:171], v[52:55], a[168:171], v[168:171]
    ds_read_b128 a[192:195], v21 offset:0
    v_mfma_f32_16x16x32_bf16 v[172:175], v[52:55], a[172:175], v[172:175]
    ds_read_b128 v[52:55], v13 offset:20480
    buffer_load_dwordx4 v11, s[8:11], s55 offen offset:1024 lds
    v_cvt_pk_bf16_f32 v72, v242, v246
    v_add_u32_e32 v8, 9437184, v9
    v_cvt_pk_bf16_f32 v76, v243, v247
    v_mfma_f32_16x16x32_bf16 v[144:147], v[56:59], a[176:179], v[144:147]
    ds_read_b128 a[196:199], v21 offset:1024
    buffer_load_dwordx4 v[192:195], v8, s[12:15], s60 offen
    v_mfma_f32_16x16x32_bf16 v[148:151], v[56:59], a[180:183], v[148:151]
    s_waitcnt vmcnt(11)
    v_or3_b32 v24, v24, v248, v252
    v_fma_mix_f32 v248, v248, v30, v34 op_sel_hi:[1,0,0]
    v_mfma_f32_16x16x32_bf16 v[152:155], v[56:59], a[184:187], v[152:155]
    v_fma_mix_f32 v252, v252, v30, v34 op_sel_hi:[1,0,0]
    ds_read_b128 a[200:203], v21 offset:2048
    v_mfma_f32_16x16x32_bf16 v[156:159], v[56:59], a[188:191], v[156:159]
    ds_read_b128 v[56:59], v12 offset:24576
    v_or3_b32 v25, v25, v249, v253
    v_fma_mix_f32 v249, v249, v31, v35 op_sel_hi:[1,0,0]
    v_fma_mix_f32 v253, v253, v31, v35 op_sel_hi:[1,0,0]
    v_mfma_f32_16x16x32_bf16 v[160:163], v[60:63], a[176:179], v[160:163]
    v_or3_b32 v24, v24, v250, v254
    ds_read_b128 a[204:207], v21 offset:3072
    v_mfma_f32_16x16x32_bf16 v[164:167], v[60:63], a[180:183], v[164:167]
    buffer_load_dwordx4 v[196:199], v8, s[12:15], s61 offen
    v_fma_mix_f32 v250, v250, v32, v36 op_sel_hi:[1,0,0]
    v_mfma_f32_16x16x32_bf16 v[168:171], v[60:63], a[184:187], v[168:171]
    v_fma_mix_f32 v254, v254, v32, v36 op_sel_hi:[1,0,0]
    ds_read_b128 a[208:211], v21 offset:4096
    v_mfma_f32_16x16x32_bf16 v[172:175], v[60:63], a[188:191], v[172:175]
    ds_read_b128 v[60:63], v12 offset:28672
    v_or3_b32 v25, v25, v251, v255
    v_fma_mix_f32 v251, v251, v33, v37 op_sel_hi:[1,0,0]
    s_waitcnt lgkmcnt(5)
    v_mfma_f32_16x16x32_bf16 v[80:83], v[40:43], a[192:195], v[80:83]
    ds_read_b128 a[212:215], v21 offset:5120
    buffer_load_dwordx4 v[200:203], v8, s[12:15], s62 offen
    v_mfma_f32_16x16x32_bf16 v[84:87], v[40:43], a[196:199], v[84:87]
    v_fma_mix_f32 v255, v255, v33, v37 op_sel_hi:[1,0,0]
    v_cvt_pk_bf16_f32 v65, v248, v252
    s_waitcnt lgkmcnt(3)
    v_mfma_f32_16x16x32_bf16 v[88:91], v[40:43], a[200:203], v[88:91]
    ds_read_b128 a[216:219], v21 offset:6144
    v_mfma_f32_16x16x32_bf16 v[92:95], v[40:43], a[204:207], v[92:95]
    ds_read_b128 v[40:43], v13 offset:24576
    v_cvt_pk_bf16_f32 v69, v249, v253
    v_cvt_pk_bf16_f32 v73, v250, v254
    v_cvt_pk_bf16_f32 v77, v251, v255
    v_mfma_f32_16x16x32_bf16 v[96:99], v[44:47], a[192:195], v[96:99]
    ds_read_b128 a[220:223], v21 offset:7168
    buffer_load_dwordx4 v[204:207], v8, s[12:15], s63 offen
    v_mfma_f32_16x16x32_bf16 v[100:103], v[44:47], a[196:199], v[100:103]
    s_waitcnt vmcnt(12)
    v_or3_b32 v24, v24, v176, v180
    v_mfma_f32_16x16x32_bf16 v[104:107], v[44:47], a[200:203], v[104:107]
    v_fma_mix_f32 v176, v176, v30, v34 op_sel_hi:[1,0,0]
    v_fma_mix_f32 v180, v180, v30, v34 op_sel_hi:[1,0,0]
    v_mfma_f32_16x16x32_bf16 v[108:111], v[44:47], a[204:207], v[108:111]
    ds_read_b128 v[44:47], v13 offset:28672
    buffer_load_dwordx4 v[208:211], v8, s[12:15], s64 offen
    s_waitcnt vmcnt(11)
    v_or3_b32 v24, v24, v184, v188
    v_fma_mix_f32 v184, v184, v30, v34 op_sel_hi:[1,0,0]
    s_waitcnt lgkmcnt(4)
    v_mfma_f32_16x16x32_bf16 v[80:83], v[48:51], a[208:211], v[80:83]
    v_fma_mix_f32 v188, v188, v30, v34 op_sel_hi:[1,0,0]
    v_cvt_pk_bf16_f32 v66, v176, v180
    v_mfma_f32_16x16x32_bf16 v[84:87], v[48:51], a[212:215], v[84:87]
    v_cvt_pk_bf16_f32 v67, v184, v188
    v_or3_b32 v25, v25, v177, v181
    s_waitcnt lgkmcnt(1)
    v_mfma_f32_16x16x32_bf16 v[88:91], v[48:51], a[216:219], v[88:91]
    v_mfma_f32_16x16x32_bf16 v[92:95], v[48:51], a[220:223], v[92:95]
    ds_read_b128 v[48:51], v12 offset:32768
    buffer_load_dwordx4 v[212:215], v8, s[12:15], s65 offen
    v_fma_mix_f32 v177, v177, v31, v35 op_sel_hi:[1,0,0]
    v_fma_mix_f32 v181, v181, v31, v35 op_sel_hi:[1,0,0]
    v_mfma_f32_16x16x32_bf16 v[96:99], v[52:55], a[208:211], v[96:99]
    v_or3_b32 v25, v25, v185, v189
    v_fma_mix_f32 v185, v185, v31, v35 op_sel_hi:[1,0,0]
    v_mfma_f32_16x16x32_bf16 v[100:103], v[52:55], a[212:215], v[100:103]
    ds_write_b128 v20, v[64:67] offset:16384
    v_fma_mix_f32 v189, v189, v31, v35 op_sel_hi:[1,0,0]
    v_mfma_f32_16x16x32_bf16 v[104:107], v[52:55], a[216:219], v[104:107]
    v_cvt_pk_bf16_f32 v70, v177, v181
    v_cvt_pk_bf16_f32 v71, v185, v189
    v_mfma_f32_16x16x32_bf16 v[108:111], v[52:55], a[220:223], v[108:111]
    buffer_load_dwordx4 v[216:219], v8, s[12:15], s66 offen
    v_or3_b32 v24, v24, v178, v182
    v_mfma_f32_16x16x32_bf16 v[112:115], v[56:59], a[192:195], v[112:115]
    ds_read_b128 v[52:55], v12 offset:36864
    buffer_load_dwordx4 v[220:223], v8, s[12:15], s67 offen
    v_mfma_f32_16x16x32_bf16 v[116:119], v[56:59], a[196:199], v[116:119]
    s_add_u32 m0, s43, 73728
    v_fma_mix_f32 v178, v178, v32, v36 op_sel_hi:[1,0,0]
    v_mfma_f32_16x16x32_bf16 v[120:123], v[56:59], a[200:203], v[120:123]
    v_fma_mix_f32 v182, v182, v32, v36 op_sel_hi:[1,0,0]
    v_or3_b32 v24, v24, v186, v190
    v_mfma_f32_16x16x32_bf16 v[124:127], v[56:59], a[204:207], v[124:127]
    ds_write_b128 v20, v[68:71] offset:17408
    v_fma_mix_f32 v186, v186, v32, v36 op_sel_hi:[1,0,0]
    v_mfma_f32_16x16x32_bf16 v[128:131], v[60:63], a[192:195], v[128:131]
    v_fma_mix_f32 v190, v190, v32, v36 op_sel_hi:[1,0,0]
    v_cvt_pk_bf16_f32 v74, v178, v182
    v_mfma_f32_16x16x32_bf16 v[132:135], v[60:63], a[196:199], v[132:135]
    buffer_load_dwordx4 v11, s[8:11], s51 offen lds
    v_cvt_pk_bf16_f32 v75, v186, v190
    v_mfma_f32_16x16x32_bf16 v[136:139], v[60:63], a[200:203], v[136:139]
    v_or3_b32 v25, v25, v179, v183
    ds_read_b128 v[56:59], v13 offset:32768
    v_mfma_f32_16x16x32_bf16 v[140:143], v[60:63], a[204:207], v[140:143]
    ds_read_b128 v[60:63], v13 offset:36864
    v_fma_mix_f32 v179, v179, v33, v37 op_sel_hi:[1,0,0]
    v_fma_mix_f32 v183, v183, v33, v37 op_sel_hi:[1,0,0]
    v_or3_b32 v25, v25, v187, v191
    v_mfma_f32_16x16x32_bf16 v[112:115], v[40:43], a[208:211], v[112:115]
    ds_write_b128 v20, v[72:75] offset:18432
    v_fma_mix_f32 v187, v187, v33, v37 op_sel_hi:[1,0,0]
    v_mfma_f32_16x16x32_bf16 v[116:119], v[40:43], a[212:215], v[116:119]
    v_fma_mix_f32 v191, v191, v33, v37 op_sel_hi:[1,0,0]
    v_cvt_pk_bf16_f32 v78, v179, v183
    v_mfma_f32_16x16x32_bf16 v[120:123], v[40:43], a[216:219], v[120:123]
    buffer_load_dwordx4 v11, s[8:11], s56 offen offset:1024 lds
    s_add_u32 m0, s43, 81920
    v_mfma_f32_16x16x32_bf16 v[124:127], v[40:43], a[220:223], v[124:127]
    v_cvt_pk_bf16_f32 v79, v187, v191
    s_waitcnt vmcnt(8)
    v_or3_b32 v24, v24, v192, v196
    s_waitcnt lgkmcnt(3)
    v_mfma_f32_16x16x32_bf16 v[128:131], v[44:47], a[208:211], v[128:131]
    ds_read_b128 v[40:43], v12 offset:40960
    buffer_load_dwordx4 v11, s[8:11], s52 offen lds
    v_mfma_f32_16x16x32_bf16 v[132:135], v[44:47], a[212:215], v[132:135]
    v_fma_mix_f32 v192, v192, v30, v34 op_sel_hi:[1,0,0]
    v_fma_mix_f32 v196, v196, v30, v34 op_sel_hi:[1,0,0]
    v_or3_b32 v25, v25, v193, v197
    v_fma_mix_f32 v193, v193, v31, v35 op_sel_hi:[1,0,0]
    v_mfma_f32_16x16x32_bf16 v[136:139], v[44:47], a[216:219], v[136:139]
    ds_write_b128 v20, v[76:79] offset:19456
    v_fma_mix_f32 v197, v197, v31, v35 op_sel_hi:[1,0,0]
    v_mfma_f32_16x16x32_bf16 v[140:143], v[44:47], a[220:223], v[140:143]
    v_or3_b32 v24, v24, v194, v198
    v_fma_mix_f32 v194, v194, v32, v36 op_sel_hi:[1,0,0]
    v_mfma_f32_16x16x32_bf16 v[144:147], v[48:51], a[192:195], v[144:147]
    buffer_load_dwordx4 v11, s[8:11], s57 offen offset:1024 lds
    s_add_u32 m0, s43, 90112
    v_mfma_f32_16x16x32_bf16 v[148:151], v[48:51], a[196:199], v[148:151]
    v_add_u32_e32 v11, s76, v10
    v_fma_mix_f32 v198, v198, v32, v36 op_sel_hi:[1,0,0]
    v_or3_b32 v25, v25, v195, v199
    v_mfma_f32_16x16x32_bf16 v[152:155], v[48:51], a[200:203], v[152:155]
    v_fma_mix_f32 v195, v195, v33, v37 op_sel_hi:[1,0,0]
    ds_read_b128 v[44:47], v12 offset:45056
    v_mfma_f32_16x16x32_bf16 v[156:159], v[48:51], a[204:207], v[156:159]
    ds_read_b128 v[48:51], v13 offset:40960
    v_fma_mix_f32 v199, v199, v33, v37 op_sel_hi:[1,0,0]
    v_mfma_f32_16x16x32_bf16 v[160:163], v[52:55], a[192:195], v[160:163]
    v_cvt_pk_bf16_f32 v64, v192, v196
    v_cvt_pk_bf16_f32 v68, v193, v197
    v_mfma_f32_16x16x32_bf16 v[164:167], v[52:55], a[196:199], v[164:167]
    s_waitcnt lgkmcnt(2)
    s_barrier
    v_mfma_f32_16x16x32_bf16 v[168:171], v[52:55], a[200:203], v[168:171]
    ds_read_b128 a[224:227], v21 offset:16384
    v_mfma_f32_16x16x32_bf16 v[172:175], v[52:55], a[204:207], v[172:175]
    ds_read_b128 v[52:55], v13 offset:45056
    buffer_load_dwordx4 v11, s[8:11], s53 offen lds
    v_cvt_pk_bf16_f32 v72, v194, v198
    v_cvt_pk_bf16_f32 v76, v195, v199
    s_waitcnt vmcnt(9)
    v_mfma_f32_16x16x32_bf16 v[144:147], v[56:59], a[208:211], v[144:147]
    ds_read_b128 a[228:231], v21 offset:17408
    buffer_load_dwordx4 v11, s[8:11], s58 offen offset:1024 lds
    v_mfma_f32_16x16x32_bf16 v[148:151], v[56:59], a[212:215], v[148:151]
    s_add_u32 m0, s43, 98304
    v_add_u32_e32 v11, 128, v10
    v_or3_b32 v24, v24, v200, v204
    v_mfma_f32_16x16x32_bf16 v[152:155], v[56:59], a[216:219], v[152:155]
    v_fma_mix_f32 v200, v200, v30, v34 op_sel_hi:[1,0,0]
    ds_read_b128 a[232:235], v21 offset:18432
    v_mfma_f32_16x16x32_bf16 v[156:159], v[56:59], a[220:223], v[156:159]
    ds_read_b128 v[56:59], v12 offset:49152
    v_fma_mix_f32 v204, v204, v30, v34 op_sel_hi:[1,0,0]
    v_or3_b32 v25, v25, v201, v205
    v_fma_mix_f32 v201, v201, v31, v35 op_sel_hi:[1,0,0]
    v_mfma_f32_16x16x32_bf16 v[160:163], v[60:63], a[208:211], v[160:163]
    v_fma_mix_f32 v205, v205, v31, v35 op_sel_hi:[1,0,0]
    ds_read_b128 a[236:239], v21 offset:19456
    v_mfma_f32_16x16x32_bf16 v[164:167], v[60:63], a[212:215], v[164:167]
    v_or3_b32 v24, v24, v202, v206
    v_fma_mix_f32 v202, v202, v32, v36 op_sel_hi:[1,0,0]
    v_mfma_f32_16x16x32_bf16 v[168:171], v[60:63], a[216:219], v[168:171]
    ds_read_b128 a[240:243], v21 offset:20480
    v_mfma_f32_16x16x32_bf16 v[172:175], v[60:63], a[220:223], v[172:175]
    ds_read_b128 v[60:63], v12 offset:53248
    buffer_load_dwordx4 v11, s[8:11], s53 offen lds
    v_fma_mix_f32 v206, v206, v32, v36 op_sel_hi:[1,0,0]
    v_or3_b32 v25, v25, v203, v207
    s_waitcnt lgkmcnt(5)
    v_mfma_f32_16x16x32_bf16 v[80:83], v[40:43], a[224:227], v[80:83]
    ds_read_b128 a[244:247], v21 offset:21504
    v_fma_mix_f32 v203, v203, v33, v37 op_sel_hi:[1,0,0]
    v_mfma_f32_16x16x32_bf16 v[84:87], v[40:43], a[228:231], v[84:87]
    v_fma_mix_f32 v207, v207, v33, v37 op_sel_hi:[1,0,0]
    v_cvt_pk_bf16_f32 v65, v200, v204
    s_waitcnt lgkmcnt(3)
    v_mfma_f32_16x16x32_bf16 v[88:91], v[40:43], a[232:235], v[88:91]
    ds_read_b128 a[248:251], v21 offset:22528
    v_mfma_f32_16x16x32_bf16 v[92:95], v[40:43], a[236:239], v[92:95]
    ds_read_b128 v[40:43], v13 offset:49152
    buffer_load_dwordx4 v11, s[8:11], s58 offen offset:1024 lds
    s_add_u32 m0, s43, 106496
    v_add_u32_e32 v11, 256, v10
    v_cvt_pk_bf16_f32 v69, v201, v205
    v_mfma_f32_16x16x32_bf16 v[96:99], v[44:47], a[224:227], v[96:99]
    ds_read_b128 a[252:255], v21 offset:23552
    v_cvt_pk_bf16_f32 v73, v202, v206
    v_mfma_f32_16x16x32_bf16 v[100:103], v[44:47], a[228:231], v[100:103]
    v_cvt_pk_bf16_f32 v77, v203, v207
    s_waitcnt vmcnt(10)
    v_mfma_f32_16x16x32_bf16 v[104:107], v[44:47], a[232:235], v[104:107]
    v_or3_b32 v24, v24, v208, v212
    v_fma_mix_f32 v208, v208, v30, v34 op_sel_hi:[1,0,0]
    v_mfma_f32_16x16x32_bf16 v[108:111], v[44:47], a[236:239], v[108:111]
    ds_read_b128 v[44:47], v13 offset:53248
    v_fma_mix_f32 v212, v212, v30, v34 op_sel_hi:[1,0,0]
    s_waitcnt vmcnt(8)
    v_or3_b32 v24, v24, v216, v220
    v_fma_mix_f32 v216, v216, v30, v34 op_sel_hi:[1,0,0]
    s_waitcnt lgkmcnt(4)
    v_mfma_f32_16x16x32_bf16 v[80:83], v[48:51], a[240:243], v[80:83]
    buffer_load_dwordx4 v11, s[8:11], s53 offen lds
    v_fma_mix_f32 v220, v220, v30, v34 op_sel_hi:[1,0,0]
    v_mfma_f32_16x16x32_bf16 v[84:87], v[48:51], a[244:247], v[84:87]
    v_cvt_pk_bf16_f32 v66, v208, v212
    v_cvt_pk_bf16_f32 v67, v216, v220
    v_or3_b32 v25, v25, v209, v213
    s_waitcnt lgkmcnt(1)
    v_mfma_f32_16x16x32_bf16 v[88:91], v[48:51], a[248:251], v[88:91]
    v_mfma_f32_16x16x32_bf16 v[92:95], v[48:51], a[252:255], v[92:95]
    ds_read_b128 v[48:51], v12 offset:57344
    v_fma_mix_f32 v209, v209, v31, v35 op_sel_hi:[1,0,0]
    v_fma_mix_f32 v213, v213, v31, v35 op_sel_hi:[1,0,0]
    v_or3_b32 v25, v25, v217, v221
    v_mfma_f32_16x16x32_bf16 v[96:99], v[52:55], a[240:243], v[96:99]
    ds_write_b128 v20, v[64:67] offset:0
    v_mfma_f32_16x16x32_bf16 v[100:103], v[52:55], a[244:247], v[100:103]
    v_fma_mix_f32 v217, v217, v31, v35 op_sel_hi:[1,0,0]
    v_fma_mix_f32 v221, v221, v31, v35 op_sel_hi:[1,0,0]
    v_mfma_f32_16x16x32_bf16 v[104:107], v[52:55], a[248:251], v[104:107]
    v_cvt_pk_bf16_f32 v70, v209, v213
    buffer_load_dwordx4 v11, s[8:11], s58 offen offset:1024 lds
    v_mfma_f32_16x16x32_bf16 v[108:111], v[52:55], a[252:255], v[108:111]
    s_add_u32 m0, s43, 114688
    v_add_u32_e32 v11, 384, v10
    v_mfma_f32_16x16x32_bf16 v[112:115], v[56:59], a[224:227], v[112:115]
    v_cvt_pk_bf16_f32 v71, v217, v221
    ds_read_b128 v[52:55], v12 offset:61440
    v_mfma_f32_16x16x32_bf16 v[116:119], v[56:59], a[228:231], v[116:119]
    v_or3_b32 v24, v24, v210, v214
    v_fma_mix_f32 v210, v210, v32, v36 op_sel_hi:[1,0,0]
    v_mfma_f32_16x16x32_bf16 v[120:123], v[56:59], a[232:235], v[120:123]
    v_fma_mix_f32 v214, v214, v32, v36 op_sel_hi:[1,0,0]
    v_or3_b32 v24, v24, v218, v222
    v_mfma_f32_16x16x32_bf16 v[124:127], v[56:59], a[236:239], v[124:127]
    ds_write_b128 v20, v[68:71] offset:1024
    v_fma_mix_f32 v218, v218, v32, v36 op_sel_hi:[1,0,0]
    v_mfma_f32_16x16x32_bf16 v[128:131], v[60:63], a[224:227], v[128:131]
    v_fma_mix_f32 v222, v222, v32, v36 op_sel_hi:[1,0,0]
    v_cvt_pk_bf16_f32 v74, v210, v214
    v_mfma_f32_16x16x32_bf16 v[132:135], v[60:63], a[228:231], v[132:135]
    buffer_load_dwordx4 v11, s[8:11], s53 offen lds
    v_cvt_pk_bf16_f32 v75, v218, v222
    v_mfma_f32_16x16x32_bf16 v[136:139], v[60:63], a[232:235], v[136:139]
    v_or3_b32 v25, v25, v211, v215
    ds_read_b128 v[56:59], v13 offset:57344
    v_mfma_f32_16x16x32_bf16 v[140:143], v[60:63], a[236:239], v[140:143]
    ds_read_b128 v[60:63], v13 offset:61440
    buffer_load_dwordx4 v11, s[8:11], s58 offen offset:1024 lds
    s_add_u32 m0, s43, 122880
    v_add_u32_e32 v11, 512, v10
    v_fma_mix_f32 v211, v211, v33, v37 op_sel_hi:[1,0,0]
    v_mfma_f32_16x16x32_bf16 v[112:115], v[40:43], a[240:243], v[112:115]
    ds_write_b128 v20, v[72:75] offset:2048
    v_fma_mix_f32 v215, v215, v33, v37 op_sel_hi:[1,0,0]
    v_mfma_f32_16x16x32_bf16 v[116:119], v[40:43], a[244:247], v[116:119]
    v_or3_b32 v25, v25, v219, v223
    v_fma_mix_f32 v219, v219, v33, v37 op_sel_hi:[1,0,0]
    v_mfma_f32_16x16x32_bf16 v[120:123], v[40:43], a[248:251], v[120:123]
    v_fma_mix_f32 v223, v223, v33, v37 op_sel_hi:[1,0,0]
    v_cvt_pk_bf16_f32 v78, v211, v215
    v_mfma_f32_16x16x32_bf16 v[124:127], v[40:43], a[252:255], v[124:127]
    v_cvt_pk_bf16_f32 v79, v219, v223
    s_waitcnt lgkmcnt(3)
    v_mfma_f32_16x16x32_bf16 v[128:131], v[44:47], a[240:243], v[128:131]
    ds_read_b128 v[40:43], v14 offset:0
    buffer_load_dwordx4 v11, s[8:11], s53 offen lds
    v_mfma_f32_16x16x32_bf16 v[132:135], v[44:47], a[244:247], v[132:135]
    v_mfma_f32_16x16x32_bf16 v[136:139], v[44:47], a[248:251], v[136:139]
    ds_write_b128 v20, v[76:79] offset:3072
    v_mfma_f32_16x16x32_bf16 v[140:143], v[44:47], a[252:255], v[140:143]
    v_mfma_f32_16x16x32_bf16 v[144:147], v[48:51], a[224:227], v[144:147]
    buffer_load_dwordx4 v11, s[8:11], s58 offen offset:1024 lds
    s_add_u32 m0, s43, 0
    v_mfma_f32_16x16x32_bf16 v[148:151], v[48:51], a[228:231], v[148:151]
    v_add_u32_e32 v11, 640, v10
    v_mfma_f32_16x16x32_bf16 v[152:155], v[48:51], a[232:235], v[152:155]
    ds_read_b128 v[44:47], v14 offset:4096
    v_mfma_f32_16x16x32_bf16 v[156:159], v[48:51], a[236:239], v[156:159]
    ds_read_b128 v[48:51], v15 offset:0
    v_mfma_f32_16x16x32_bf16 v[160:163], v[52:55], a[224:227], v[160:163]
    v_mfma_f32_16x16x32_bf16 v[164:167], v[52:55], a[228:231], v[164:167]
    s_waitcnt vmcnt(10) lgkmcnt(2)
    s_barrier
    v_mfma_f32_16x16x32_bf16 v[168:171], v[52:55], a[232:235], v[168:171]
    ds_read_b128 v[224:227], v21 offset:0
    v_mfma_f32_16x16x32_bf16 v[172:175], v[52:55], a[236:239], v[172:175]
    ds_read_b128 v[52:55], v15 offset:4096
    buffer_load_dwordx4 v11, s[8:11], s53 offen lds
    v_or_b32_e32 v24, v24, v25
    v_cmp_lt_u32_e32 vcc, 15, v24
    s_or_b64 s[48:49], s[46:47], vcc
    s_cmp_lg_u64 s[48:49], 0
    s_cselect_b32 s36, 1, 0
    v_mfma_f32_16x16x32_bf16 v[144:147], v[56:59], a[240:243], v[144:147]
    ds_read_b128 v[228:231], v21 offset:1024
    v_lshlrev_b32_e32 v3, 2, v1
    v_mfma_f32_16x16x32_bf16 v[148:151], v[56:59], a[244:247], v[148:151]
    v_mov_b32_e32 v4, s36
    v_add_u32_e32 v3, 147456, v3
    v_mov_b32_e32 v5, 147456
    s_mov_b32 vcc_lo, 0xff00ff
    v_mfma_f32_16x16x32_bf16 v[152:155], v[56:59], a[248:251], v[152:155]
    s_mov_b32 vcc_hi, 0xff00ff
    ds_read_b128 v[232:235], v21 offset:2048
    v_mfma_f32_16x16x32_bf16 v[156:159], v[56:59], a[252:255], v[156:159]
    ds_read_b128 v[56:59], v14 offset:8192
    buffer_load_dwordx4 v11, s[8:11], s58 offen offset:1024 lds
    s_add_u32 m0, s43, 8192
    v_mfma_f32_16x16x32_bf16 v[160:163], v[60:63], a[240:243], v[160:163]
    v_add_u32_e32 v11, 768, v10
    ds_read_b128 v[236:239], v21 offset:3072
    v_mfma_f32_16x16x32_bf16 v[164:167], v[60:63], a[244:247], v[164:167]
    v_mfma_f32_16x16x32_bf16 v[168:171], v[60:63], a[248:251], v[168:171]
    ds_read_b128 v[240:243], v21 offset:4096
    v_mfma_f32_16x16x32_bf16 v[172:175], v[60:63], a[252:255], v[172:175]
    ds_read_b128 v[60:63], v14 offset:12288
    s_waitcnt lgkmcnt(5)
    v_mfma_f32_16x16x32_bf16 v[80:83], v[40:43], v[224:227], v[80:83]
    ds_read_b128 v[244:247], v21 offset:5120
    buffer_load_dwordx4 v11, s[8:11], s53 offen lds
    v_mfma_f32_16x16x32_bf16 v[84:87], v[40:43], v[228:231], v[84:87]
    s_waitcnt lgkmcnt(3)
    v_mfma_f32_16x16x32_bf16 v[88:91], v[40:43], v[232:235], v[88:91]
    ds_read_b128 v[248:251], v21 offset:6144
    v_mfma_f32_16x16x32_bf16 v[92:95], v[40:43], v[236:239], v[92:95]
    ds_read_b128 v[40:43], v15 offset:8192
    v_mfma_f32_16x16x32_bf16 v[96:99], v[44:47], v[224:227], v[96:99]
    ds_read_b128 v[252:255], v21 offset:7168
    buffer_load_dwordx4 v11, s[8:11], s58 offen offset:1024 lds
    v_mfma_f32_16x16x32_bf16 v[100:103], v[44:47], v[228:231], v[100:103]
    s_add_u32 m0, s43, 16384
    v_add_u32_e32 v11, 896, v10
    v_mfma_f32_16x16x32_bf16 v[104:107], v[44:47], v[232:235], v[104:107]
    ds_write_b32 v3, v4
    v_mfma_f32_16x16x32_bf16 v[108:111], v[44:47], v[236:239], v[108:111]
    ds_read_b128 v[44:47], v15 offset:12288
    s_waitcnt lgkmcnt(5)
    v_mfma_f32_16x16x32_bf16 v[80:83], v[48:51], v[240:243], v[80:83]
    v_mfma_f32_16x16x32_bf16 v[84:87], v[48:51], v[244:247], v[84:87]
    s_waitcnt lgkmcnt(2)
    v_mfma_f32_16x16x32_bf16 v[88:91], v[48:51], v[248:251], v[88:91]
    v_mfma_f32_16x16x32_bf16 v[92:95], v[48:51], v[252:255], v[92:95]
    ds_read_b128 v[48:51], v14 offset:16384
    buffer_load_dwordx4 v11, s[8:11], s53 offen lds
    v_mfma_f32_16x16x32_bf16 v[96:99], v[52:55], v[240:243], v[96:99]
    v_mfma_f32_16x16x32_bf16 v[100:103], v[52:55], v[244:247], v[100:103]
    v_mfma_f32_16x16x32_bf16 v[104:107], v[52:55], v[248:251], v[104:107]
    v_mfma_f32_16x16x32_bf16 v[108:111], v[52:55], v[252:255], v[108:111]
    ds_read_b128 v[52:55], v14 offset:20480
    buffer_load_dwordx4 v11, s[8:11], s58 offen offset:1024 lds
    v_lshl_add_u32 v23, s85, 3, v22
    v_cvt_pk_bf16_f32 v80, v80, v84
    v_cvt_pk_bf16_f32 v81, v81, v85
    v_cvt_pk_bf16_f32 v82, v82, v86
    v_mfma_f32_16x16x32_bf16 v[112:115], v[56:59], v[224:227], v[112:115]
    v_cvt_pk_bf16_f32 v83, v83, v87
    v_cvt_pk_bf16_f32 v88, v88, v92
    v_mfma_f32_16x16x32_bf16 v[116:119], v[56:59], v[228:231], v[116:119]
    v_cvt_pk_bf16_f32 v89, v89, v93
    v_cvt_pk_bf16_f32 v90, v90, v94
    v_mfma_f32_16x16x32_bf16 v[120:123], v[56:59], v[232:235], v[120:123]
    v_cvt_pk_bf16_f32 v91, v91, v95
    v_cndmask_b32_dpp v84, v81, v80, vcc row_ror:8 row_mask:0xf bank_mask:0xf
    v_mfma_f32_16x16x32_bf16 v[124:127], v[56:59], v[236:239], v[124:127]
    ds_read_b128 v[56:59], v15 offset:16384
    v_cndmask_b32_dpp v85, v89, v88, vcc row_ror:8 row_mask:0xf bank_mask:0xf
    s_not_b64 vcc, vcc
L_tF2:
    s_cbranch_execz L_retF
    v_mfma_f32_16x16x32_bf16 v[128:131], v[60:63], v[224:227], v[128:131]
    v_cndmask_b32_dpp v86, v80, v81, vcc row_ror:8 row_mask:0xf bank_mask:0xf
    v_cndmask_b32_dpp v87, v88, v89, vcc row_ror:8 row_mask:0xf bank_mask:0xf
    v_mfma_f32_16x16x32_bf16 v[132:135], v[60:63], v[228:231], v[132:135]
    buffer_store_dwordx4 v[84:87], v23, s[24:27], 0 offen sc1
    v_cndmask_b32_dpp v94, v82, v83, vcc row_ror:8 row_mask:0xf bank_mask:0xf
    v_mfma_f32_16x16x32_bf16 v[136:139], v[60:63], v[232:235], v[136:139]
    v_cndmask_b32_dpp v95, v90, v91, vcc row_ror:8 row_mask:0xf bank_mask:0xf
    s_not_b64 vcc, vcc
    v_mfma_f32_16x16x32_bf16 v[140:143], v[60:63], v[236:239], v[140:143]
    v_cndmask_b32_dpp v92, v83, v82, vcc row_ror:8 row_mask:0xf bank_mask:0xf
    v_cndmask_b32_dpp v93, v91, v90, vcc row_ror:8 row_mask:0xf bank_mask:0xf
    v_mfma_f32_16x16x32_bf16 v[112:115], v[40:43], v[240:243], v[112:115]
    s_add_u32 m0, s43, 24576
    v_add_u32_e32 v11, 1024, v10
    v_mfma_f32_16x16x32_bf16 v[116:119], v[40:43], v[244:247], v[116:119]
    ds_read_b128 v[60:63], v15 offset:20480
    buffer_load_dwordx4 v11, s[8:11], s53 offen lds
    v_mfma_f32_16x16x32_bf16 v[120:123], v[40:43], v[248:251], v[120:123]
    buffer_load_dwordx4 v11, s[8:11], s58 offen offset:1024 lds
    s_add_u32 m0, s43, 32768
    v_mfma_f32_16x16x32_bf16 v[124:127], v[40:43], v[252:255], v[124:127]
    v_add_u32_e32 v11, s76, v10
    s_waitcnt lgkmcnt(1)
    v_mfma_f32_16x16x32_bf16 v[128:131], v[44:47], v[240:243], v[128:131]
    v_mfma_f32_16x16x32_bf16 v[132:135], v[44:47], v[244:247], v[132:135]
    s_waitcnt vmcnt(9)
    s_barrier
    v_mfma_f32_16x16x32_bf16 v[136:139], v[44:47], v[248:251], v[136:139]
    ds_read_b128 v[40:43], v14 offset:24576
    v_mfma_f32_16x16x32_bf16 v[140:143], v[44:47], v[252:255], v[140:143]
    ds_read_b128 v[44:47], v14 offset:28672
    ds_read_b128 v[4:7], v5
    v_mfma_f32_16x16x32_bf16 v[144:147], v[48:51], v[224:227], v[144:147]
    buffer_load_dwordx4 v11, s[8:11], s54 offen lds
    v_mfma_f32_16x16x32_bf16 v[148:151], v[48:51], v[228:231], v[148:151]
    v_mfma_f32_16x16x32_bf16 v[152:155], v[48:51], v[232:235], v[152:155]
    v_mfma_f32_16x16x32_bf16 v[156:159], v[48:51], v[236:239], v[156:159]
    ds_read_b128 v[48:51], v15 offset:24576
    v_mfma_f32_16x16x32_bf16 v[160:163], v[52:55], v[224:227], v[160:163]
    buffer_store_dwordx4 v[92:95], v23, s[24:27], s73 offen sc1
    v_mfma_f32_16x16x32_bf16 v[164:167], v[52:55], v[228:231], v[164:167]
    v_mfma_f32_16x16x32_bf16 v[168:171], v[52:55], v[232:235], v[168:171]
    v_mfma_f32_16x16x32_bf16 v[172:175], v[52:55], v[236:239], v[172:175]
    ds_read_b128 v[52:55], v15 offset:28672
    v_cvt_pk_bf16_f32 v96, v96, v100
    v_cvt_pk_bf16_f32 v97, v97, v101
    v_cvt_pk_bf16_f32 v98, v98, v102
    v_cvt_pk_bf16_f32 v99, v99, v103
    v_cvt_pk_bf16_f32 v104, v104, v108
    v_mfma_f32_16x16x32_bf16 v[144:147], v[56:59], v[240:243], v[144:147]
    buffer_load_dwordx4 v11, s[8:11], s59 offen offset:1024 lds
    v_cvt_pk_bf16_f32 v105, v105, v109
    v_mfma_f32_16x16x32_bf16 v[148:151], v[56:59], v[244:247], v[148:151]
    v_cvt_pk_bf16_f32 v106, v106, v110
    v_cvt_pk_bf16_f32 v107, v107, v111
    v_mfma_f32_16x16x32_bf16 v[152:155], v[56:59], v[248:251], v[152:155]
    v_cndmask_b32_dpp v100, v97, v96, vcc row_ror:8 row_mask:0xf bank_mask:0xf
    v_cndmask_b32_dpp v101, v105, v104, vcc row_ror:8 row_mask:0xf bank_mask:0xf
    v_mfma_f32_16x16x32_bf16 v[156:159], v[56:59], v[252:255], v[156:159]
    ds_read_b128 v[56:59], v14 offset:32768
    s_not_b64 vcc, vcc
    v_cndmask_b32_dpp v102, v96, v97, vcc row_ror:8 row_mask:0xf bank_mask:0xf
    v_cndmask_b32_dpp v103, v104, v105, vcc row_ror:8 row_mask:0xf bank_mask:0xf
    s_waitcnt lgkmcnt(3)
    v_or3_b32 v4, v4, v5, v6
    v_or_b32_e32 v4, v4, v7
    s_nop 0
    v_readfirstlane_b32_e32 s36, v4
    s_cmp_lg_u32 s36, 0
    s_cbranch_scc1 L_slow
    v_mfma_f32_16x16x32_bf16 v[160:163], v[60:63], v[240:243], v[160:163]
    s_add_u32 m0, s43, 40960
    v_add_u32_e32 v11, 128, v10
    v_mfma_f32_16x16x32_bf16 v[164:167], v[60:63], v[244:247], v[164:167]
    v_mfma_f32_16x16x32_bf16 v[168:171], v[60:63], v[248:251], v[168:171]
    v_mfma_f32_16x16x32_bf16 v[172:175], v[60:63], v[252:255], v[172:175]
    ds_read_b128 v[60:63], v14 offset:36864
    v_mfma_f32_16x16x32_bf16 v[176:179], v[40:43], a[0:3], 0
    buffer_load_dwordx4 v11, s[8:11], s54 offen lds
    v_mfma_f32_16x16x32_bf16 v[180:183], v[40:43], a[4:7], 0
    v_mfma_f32_16x16x32_bf16 v[184:187], v[40:43], a[8:11], 0
    v_mfma_f32_16x16x32_bf16 v[188:191], v[40:43], a[12:15], 0
    ds_read_b128 v[40:43], v15 offset:32768
    v_mfma_f32_16x16x32_bf16 v[192:195], v[44:47], a[0:3], 0
    v_mfma_f32_16x16x32_bf16 v[196:199], v[44:47], a[4:7], 0
    v_mfma_f32_16x16x32_bf16 v[200:203], v[44:47], a[8:11], 0
    v_mfma_f32_16x16x32_bf16 v[204:207], v[44:47], a[12:15], 0
    ds_read_b128 v[44:47], v15 offset:36864
    s_waitcnt lgkmcnt(2)
    v_mfma_f32_16x16x32_bf16 v[176:179], v[48:51], a[16:19], v[176:179]
    buffer_load_dwordx4 v11, s[8:11], s59 offen offset:1024 lds
    s_add_u32 m0, s43, 49152
    v_mfma_f32_16x16x32_bf16 v[180:183], v[48:51], a[20:23], v[180:183]
    v_add_u32_e32 v11, 256, v10
    v_mfma_f32_16x16x32_bf16 v[184:187], v[48:51], a[24:27], v[184:187]
    v_mfma_f32_16x16x32_bf16 v[188:191], v[48:51], a[28:31], v[188:191]
    ds_read_b128 v[48:51], v14 offset:40960
    buffer_store_dwordx4 v[100:103], v23, s[24:27], s74 offen sc1
    v_mfma_f32_16x16x32_bf16 v[192:195], v[52:55], a[16:19], v[192:195]
    v_cndmask_b32_dpp v110, v98, v99, vcc row_ror:8 row_mask:0xf bank_mask:0xf
    v_cndmask_b32_dpp v111, v106, v107, vcc row_ror:8 row_mask:0xf bank_mask:0xf
    v_mfma_f32_16x16x32_bf16 v[196:199], v[52:55], a[20:23], v[196:199]
    s_not_b64 vcc, vcc
    v_cndmask_b32_dpp v108, v99, v98, vcc row_ror:8 row_mask:0xf bank_mask:0xf
    v_mfma_f32_16x16x32_bf16 v[200:203], v[52:55], a[24:27], v[200:203]
    v_cndmask_b32_dpp v109, v107, v106, vcc row_ror:8 row_mask:0xf bank_mask:0xf
    v_mfma_f32_16x16x32_bf16 v[204:207], v[52:55], a[28:31], v[204:207]
    ds_read_b128 v[52:55], v14 offset:45056
    v_mfma_f32_16x16x32_bf16 v[176:179], v[56:59], a[32:35], v[176:179]
    buffer_load_dwordx4 v11, s[8:11], s54 offen lds
    v_mfma_f32_16x16x32_bf16 v[180:183], v[56:59], a[36:39], v[180:183]
    v_mfma_f32_16x16x32_bf16 v[184:187], v[56:59], a[40:43], v[184:187]
    v_mfma_f32_16x16x32_bf16 v[188:191], v[56:59], a[44:47], v[188:191]
    ds_read_b128 v[56:59], v15 offset:40960
    v_mfma_f32_16x16x32_bf16 v[192:195], v[60:63], a[32:35], v[192:195]
    v_mfma_f32_16x16x32_bf16 v[196:199], v[60:63], a[36:39], v[196:199]
    v_mfma_f32_16x16x32_bf16 v[200:203], v[60:63], a[40:43], v[200:203]
    v_mfma_f32_16x16x32_bf16 v[204:207], v[60:63], a[44:47], v[204:207]
    ds_read_b128 v[60:63], v15 offset:45056
    s_waitcnt lgkmcnt(2)
    v_mfma_f32_16x16x32_bf16 v[176:179], v[40:43], a[48:51], v[176:179]
    buffer_load_dwordx4 v11, s[8:11], s59 offen offset:1024 lds
    s_add_u32 m0, s43, 57344
    v_mfma_f32_16x16x32_bf16 v[180:183], v[40:43], a[52:55], v[180:183]
    v_add_u32_e32 v11, 384, v10
    v_mfma_f32_16x16x32_bf16 v[184:187], v[40:43], a[56:59], v[184:187]
    v_mfma_f32_16x16x32_bf16 v[188:191], v[40:43], a[60:63], v[188:191]
    ds_read_b128 v[40:43], v14 offset:49152
    v_mfma_f32_16x16x32_bf16 v[192:195], v[44:47], a[48:51], v[192:195]
    buffer_store_dwordx4 v[108:111], v23, s[24:27], s75 offen sc1
    v_mfma_f32_16x16x32_bf16 v[196:199], v[44:47], a[52:55], v[196:199]
    v_mfma_f32_16x16x32_bf16 v[200:203], v[44:47], a[56:59], v[200:203]
    v_mfma_f32_16x16x32_bf16 v[204:207], v[44:47], a[60:63], v[204:207]
    ds_read_b128 v[44:47], v14 offset:53248
    v_lshl_add_u32 v23, s86, 3, v22
    v_cvt_pk_bf16_f32 v112, v112, v116
    v_mfma_f32_16x16x32_bf16 v[176:179], v[48:51], a[64:67], v[176:179]
    v_cvt_pk_bf16_f32 v113, v113, v117
    v_cvt_pk_bf16_f32 v114, v114, v118
    v_mfma_f32_16x16x32_bf16 v[180:183], v[48:51], a[68:71], v[180:183]
    v_cvt_pk_bf16_f32 v115, v115, v119
    buffer_load_dwordx4 v11, s[8:11], s54 offen lds
    v_mfma_f32_16x16x32_bf16 v[184:187], v[48:51], a[72:75], v[184:187]
    v_cvt_pk_bf16_f32 v120, v120, v124
    v_cvt_pk_bf16_f32 v121, v121, v125
    v_mfma_f32_16x16x32_bf16 v[188:191], v[48:51], a[76:79], v[188:191]
    v_cvt_pk_bf16_f32 v122, v122, v126
    v_cvt_pk_bf16_f32 v123, v123, v127
    v_mfma_f32_16x16x32_bf16 v[192:195], v[52:55], a[64:67], v[192:195]
    v_cndmask_b32_dpp v116, v113, v112, vcc row_ror:8 row_mask:0xf bank_mask:0xf
    ds_read_b128 v[48:51], v15 offset:49152
    v_mfma_f32_16x16x32_bf16 v[196:199], v[52:55], a[68:71], v[196:199]
    v_cndmask_b32_dpp v117, v121, v120, vcc row_ror:8 row_mask:0xf bank_mask:0xf
    s_not_b64 vcc, vcc
    v_mfma_f32_16x16x32_bf16 v[200:203], v[52:55], a[72:75], v[200:203]
    v_cndmask_b32_dpp v118, v112, v113, vcc row_ror:8 row_mask:0xf bank_mask:0xf
    v_cndmask_b32_dpp v119, v120, v121, vcc row_ror:8 row_mask:0xf bank_mask:0xf
    v_mfma_f32_16x16x32_bf16 v[204:207], v[52:55], a[76:79], v[204:207]
    ds_read_b128 v[52:55], v15 offset:53248
    s_waitcnt lgkmcnt(2)
    v_mfma_f32_16x16x32_bf16 v[176:179], v[56:59], a[80:83], v[176:179]
    buffer_load_dwordx4 v11, s[8:11], s59 offen offset:1024 lds
    s_add_u32 m0, s43, 65536
    v_mfma_f32_16x16x32_bf16 v[180:183], v[56:59], a[84:87], v[180:183]
    v_add_u32_e32 v11, 512, v10
    v_mfma_f32_16x16x32_bf16 v[184:187], v[56:59], a[88:91], v[184:187]
    v_mfma_f32_16x16x32_bf16 v[188:191], v[56:59], a[92:95], v[188:191]
    ds_read_b128 v[56:59], v14 offset:57344
    v_mfma_f32_16x16x32_bf16 v[192:195], v[60:63], a[80:83], v[192:195]
    v_mfma_f32_16x16x32_bf16 v[196:199], v[60:63], a[84:87], v[196:199]
    v_mfma_f32_16x16x32_bf16 v[200:203], v[60:63], a[88:91], v[200:203]
    v_mfma_f32_16x16x32_bf16 v[204:207], v[60:63], a[92:95], v[204:207]
    ds_read_b128 v[60:63], v14 offset:61440
    v_mfma_f32_16x16x32_bf16 v[176:179], v[40:43], a[96:99], v[176:179]
    buffer_load_dwordx4 v11, s[8:11], s54 offen lds
    v_mfma_f32_16x16x32_bf16 v[180:183], v[40:43], a[100:103], v[180:183]
    v_mfma_f32_16x16x32_bf16 v[184:187], v[40:43], a[104:107], v[184:187]
    v_mfma_f32_16x16x32_bf16 v[188:191], v[40:43], a[108:111], v[188:191]
    ds_read_b128 v[40:43], v15 offset:57344
    buffer_store_dwordx4 v[116:119], v23, s[24:27], 0 offen sc1
    v_mfma_f32_16x16x32_bf16 v[192:195], v[44:47], a[96:99], v[192:195]
    v_mfma_f32_16x16x32_bf16 v[196:199], v[44:47], a[100:103], v[196:199]
    s_waitcnt vmcnt(13)
    s_barrier
    v_mfma_f32_16x16x32_bf16 v[200:203], v[44:47], a[104:107], v[200:203]
    v_mfma_f32_16x16x32_bf16 v[204:207], v[44:47], a[108:111], v[204:207]
    ds_read_b128 v[44:47], v15 offset:61440
    v_cndmask_b32_dpp v126, v114, v115, vcc row_ror:8 row_mask:0xf bank_mask:0xf
    v_cndmask_b32_dpp v127, v122, v123, vcc row_ror:8 row_mask:0xf bank_mask:0xf
    s_not_b64 vcc, vcc
    v_cndmask_b32_dpp v124, v115, v114, vcc row_ror:8 row_mask:0xf bank_mask:0xf
    s_waitcnt lgkmcnt(2)
    v_mfma_f32_16x16x32_bf16 v[176:179], v[48:51], a[112:115], v[176:179]
    buffer_load_dwordx4 v11, s[8:11], s59 offen offset:1024 lds
    v_cndmask_b32_dpp v125, v123, v122, vcc row_ror:8 row_mask:0xf bank_mask:0xf
    v_mfma_f32_16x16x32_bf16 v[180:183], v[48:51], a[116:119], v[180:183]
    s_add_u32 m0, s43, 73728
    v_add_u32_e32 v11, 640, v10
    v_mfma_f32_16x16x32_bf16 v[184:187], v[48:51], a[120:123], v[184:187]
    v_mfma_f32_16x16x32_bf16 v[188:191], v[48:51], a[124:127], v[188:191]
    ds_read_b128 v[48:51], v12 offset:0
    v_mfma_f32_16x16x32_bf16 v[192:195], v[52:55], a[112:115], v[192:195]
    v_mfma_f32_16x16x32_bf16 v[196:199], v[52:55], a[116:119], v[196:199]
    v_mfma_f32_16x16x32_bf16 v[200:203], v[52:55], a[120:123], v[200:203]
    v_mfma_f32_16x16x32_bf16 v[204:207], v[52:55], a[124:127], v[204:207]
    ds_read_b128 v[52:55], v12 offset:4096
    v_mfma_f32_16x16x32_bf16 v[176:179], v[56:59], a[128:131], v[176:179]
    buffer_load_dwordx4 v11, s[8:11], s54 offen lds
    v_mfma_f32_16x16x32_bf16 v[180:183], v[56:59], a[132:135], v[180:183]
    v_mfma_f32_16x16x32_bf16 v[184:187], v[56:59], a[136:139], v[184:187]
    v_mfma_f32_16x16x32_bf16 v[188:191], v[56:59], a[140:143], v[188:191]
    ds_read_b128 v[56:59], v13 offset:0
    v_mfma_f32_16x16x32_bf16 v[192:195], v[60:63], a[128:131], v[192:195]
    buffer_store_dwordx4 v[124:127], v23, s[24:27], s73 offen sc1
    v_mfma_f32_16x16x32_bf16 v[196:199], v[60:63], a[132:135], v[196:199]
    v_mfma_f32_16x16x32_bf16 v[200:203], v[60:63], a[136:139], v[200:203]
    v_mfma_f32_16x16x32_bf16 v[204:207], v[60:63], a[140:143], v[204:207]
    ds_read_b128 v[60:63], v13 offset:4096
    v_cvt_pk_bf16_f32 v128, v128, v132
    v_cvt_pk_bf16_f32 v129, v129, v133
    v_cvt_pk_bf16_f32 v130, v130, v134
    v_cvt_pk_bf16_f32 v131, v131, v135
    s_waitcnt lgkmcnt(2)
    v_mfma_f32_16x16x32_bf16 v[176:179], v[40:43], a[144:147], v[176:179]
    buffer_load_dwordx4 v11, s[8:11], s59 offen offset:1024 lds
    v_cvt_pk_bf16_f32 v136, v136, v140
    v_mfma_f32_16x16x32_bf16 v[180:183], v[40:43], a[148:151], v[180:183]
    v_cvt_pk_bf16_f32 v137, v137, v141
    v_cvt_pk_bf16_f32 v138, v138, v142
    v_mfma_f32_16x16x32_bf16 v[184:187], v[40:43], a[152:155], v[184:187]
    v_cvt_pk_bf16_f32 v139, v139, v143
    v_cndmask_b32_dpp v132, v129, v128, vcc row_ror:8 row_mask:0xf bank_mask:0xf
    v_mfma_f32_16x16x32_bf16 v[188:191], v[40:43], a[156:159], v[188:191]
    ds_read_b128 v[40:43], v12 offset:8192
    v_cndmask_b32_dpp v133, v137, v136, vcc row_ror:8 row_mask:0xf bank_mask:0xf
    v_mfma_f32_16x16x32_bf16 v[192:195], v[44:47], a[144:147], v[192:195]
    s_not_b64 vcc, vcc
    v_cndmask_b32_dpp v134, v128, v129, vcc row_ror:8 row_mask:0xf bank_mask:0xf
    v_mfma_f32_16x16x32_bf16 v[196:199], v[44:47], a[148:151], v[196:199]
    v_cndmask_b32_dpp v135, v136, v137, vcc row_ror:8 row_mask:0xf bank_mask:0xf
    s_add_u32 m0, s43, 81920
    v_mfma_f32_16x16x32_bf16 v[200:203], v[44:47], a[152:155], v[200:203]
    v_add_u32_e32 v11, 768, v10
    v_mfma_f32_16x16x32_bf16 v[204:207], v[44:47], a[156:159], v[204:207]
    ds_read_b128 v[44:47], v12 offset:12288
    v_mfma_f32_16x16x32_bf16 v[176:179], v[48:51], a[160:163], v[176:179]
    buffer_load_dwordx4 v11, s[8:11], s54 offen lds
    v_mfma_f32_16x16x32_bf16 v[180:183], v[48:51], a[164:167], v[180:183]
    v_mfma_f32_16x16x32_bf16 v[184:187], v[48:51], a[168:171], v[184:187]
    v_mfma_f32_16x16x32_bf16 v[188:191], v[48:51], a[172:175], v[188:191]
    ds_read_b128 v[48:51], v13 offset:8192
    v_mfma_f32_16x16x32_bf16 v[192:195], v[52:55], a[160:163], v[192:195]
    v_mfma_f32_16x16x32_bf16 v[196:199], v[52:55], a[164:167], v[196:199]
    v_mfma_f32_16x16x32_bf16 v[200:203], v[52:55], a[168:171], v[200:203]
    v_mfma_f32_16x16x32_bf16 v[204:207], v[52:55], a[172:175], v[204:207]
    ds_read_b128 v[52:55], v13 offset:12288
    s_waitcnt lgkmcnt(2)
    v_mfma_f32_16x16x32_bf16 v[176:179], v[56:59], a[176:179], v[176:179]
    buffer_load_dwordx4 v11, s[8:11], s59 offen offset:1024 lds
    s_add_u32 m0, s43, 90112
    v_mfma_f32_16x16x32_bf16 v[180:183], v[56:59], a[180:183], v[180:183]
    v_add_u32_e32 v11, 896, v10
    v_mfma_f32_16x16x32_bf16 v[184:187], v[56:59], a[184:187], v[184:187]
    v_mfma_f32_16x16x32_bf16 v[188:191], v[56:59], a[188:191], v[188:191]
    ds_read_b128 v[56:59], v12 offset:16384
    buffer_store_dwordx4 v[132:135], v23, s[24:27], s74 offen sc1
    v_mfma_f32_16x16x32_bf16 v[192:195], v[60:63], a[176:179], v[192:195]
    v_cndmask_b32_dpp v142, v130, v131, vcc row_ror:8 row_mask:0xf bank_mask:0xf
    v_cndmask_b32_dpp v143, v138, v139, vcc row_ror:8 row_mask:0xf bank_mask:0xf
    v_mfma_f32_16x16x32_bf16 v[196:199], v[60:63], a[180:183], v[196:199]
    s_not_b64 vcc, vcc
    v_cndmask_b32_dpp v140, v131, v130, vcc row_ror:8 row_mask:0xf bank_mask:0xf
    v_mfma_f32_16x16x32_bf16 v[200:203], v[60:63], a[184:187], v[200:203]
    v_cndmask_b32_dpp v141, v139, v138, vcc row_ror:8 row_mask:0xf bank_mask:0xf
    v_mfma_f32_16x16x32_bf16 v[204:207], v[60:63], a[188:191], v[204:207]
    ds_read_b128 v[60:63], v12 offset:20480
    v_mfma_f32_16x16x32_bf16 v[176:179], v[40:43], a[192:195], v[176:179]
    buffer_load_dwordx4 v11, s[8:11], s54 offen lds
    v_mfma_f32_16x16x32_bf16 v[180:183], v[40:43], a[196:199], v[180:183]
    v_mfma_f32_16x16x32_bf16 v[184:187], v[40:43], a[200:203], v[184:187]
    v_mfma_f32_16x16x32_bf16 v[188:191], v[40:43], a[204:207], v[188:191]
    ds_read_b128 v[40:43], v13 offset:16384
    v_mfma_f32_16x16x32_bf16 v[192:195], v[44:47], a[192:195], v[192:195]
    v_mfma_f32_16x16x32_bf16 v[196:199], v[44:47], a[196:199], v[196:199]
    v_mfma_f32_16x16x32_bf16 v[200:203], v[44:47], a[200:203], v[200:203]
    v_mfma_f32_16x16x32_bf16 v[204:207], v[44:47], a[204:207], v[204:207]
    ds_read_b128 v[44:47], v13 offset:20480
    s_waitcnt lgkmcnt(2)
    v_mfma_f32_16x16x32_bf16 v[176:179], v[48:51], a[208:211], v[176:179]
    buffer_load_dwordx4 v11, s[8:11], s59 offen offset:1024 lds
    s_add_u32 m0, s43, 98304
    v_mfma_f32_16x16x32_bf16 v[180:183], v[48:51], a[212:215], v[180:183]
    v_add_u32_e32 v11, 1024, v10
    v_mfma_f32_16x16x32_bf16 v[184:187], v[48:51], a[216:219], v[184:187]
    v_mfma_f32_16x16x32_bf16 v[188:191], v[48:51], a[220:223], v[188:191]
    ds_read_b128 v[48:51], v12 offset:24576
    v_mfma_f32_16x16x32_bf16 v[192:195], v[52:55], a[208:211], v[192:195]
    buffer_store_dwordx4 v[140:143], v23, s[24:27], s75 offen sc1
    v_mfma_f32_16x16x32_bf16 v[196:199], v[52:55], a[212:215], v[196:199]
    v_mfma_f32_16x16x32_bf16 v[200:203], v[52:55], a[216:219], v[200:203]
    v_mfma_f32_16x16x32_bf16 v[204:207], v[52:55], a[220:223], v[204:207]
    ds_read_b128 v[52:55], v12 offset:28672
    v_lshl_add_u32 v23, s87, 3, v22
    v_cvt_pk_bf16_f32 v144, v144, v148
    v_mfma_f32_16x16x32_bf16 v[176:179], v[56:59], a[224:227], v[176:179]
    v_cvt_pk_bf16_f32 v145, v145, v149
    v_cvt_pk_bf16_f32 v146, v146, v150
    v_mfma_f32_16x16x32_bf16 v[180:183], v[56:59], a[228:231], v[180:183]
    v_cvt_pk_bf16_f32 v147, v147, v151
    buffer_load_dwordx4 v11, s[8:11], s54 offen lds
    v_mfma_f32_16x16x32_bf16 v[184:187], v[56:59], a[232:235], v[184:187]
    v_cvt_pk_bf16_f32 v152, v152, v156
    v_cvt_pk_bf16_f32 v153, v153, v157
    v_mfma_f32_16x16x32_bf16 v[188:191], v[56:59], a[236:239], v[188:191]
    v_cvt_pk_bf16_f32 v154, v154, v158
    v_cvt_pk_bf16_f32 v155, v155, v159
    v_mfma_f32_16x16x32_bf16 v[192:195], v[60:63], a[224:227], v[192:195]
    v_cndmask_b32_dpp v148, v145, v144, vcc row_ror:8 row_mask:0xf bank_mask:0xf
    ds_read_b128 v[56:59], v13 offset:24576
    v_mfma_f32_16x16x32_bf16 v[196:199], v[60:63], a[228:231], v[196:199]
    v_cndmask_b32_dpp v149, v153, v152, vcc row_ror:8 row_mask:0xf bank_mask:0xf
    s_not_b64 vcc, vcc
    v_mfma_f32_16x16x32_bf16 v[200:203], v[60:63], a[232:235], v[200:203]
    v_cndmask_b32_dpp v150, v144, v145, vcc row_ror:8 row_mask:0xf bank_mask:0xf
    v_cndmask_b32_dpp v151, v152, v153, vcc row_ror:8 row_mask:0xf bank_mask:0xf
    v_mfma_f32_16x16x32_bf16 v[204:207], v[60:63], a[236:239], v[204:207]
    ds_read_b128 v[60:63], v13 offset:28672
    s_waitcnt lgkmcnt(2)
    v_mfma_f32_16x16x32_bf16 v[176:179], v[40:43], a[240:243], v[176:179]
    buffer_load_dwordx4 v11, s[8:11], s59 offen offset:1024 lds
    v_mfma_f32_16x16x32_bf16 v[180:183], v[40:43], a[244:247], v[180:183]
    v_mfma_f32_16x16x32_bf16 v[184:187], v[40:43], a[248:251], v[184:187]
    v_mfma_f32_16x16x32_bf16 v[188:191], v[40:43], a[252:255], v[188:191]
    v_mfma_f32_16x16x32_bf16 v[192:195], v[44:47], a[240:243], v[192:195]
    v_mfma_f32_16x16x32_bf16 v[196:199], v[44:47], a[244:247], v[196:199]
    s_waitcnt vmcnt(11)
    s_barrier
    v_mfma_f32_16x16x32_bf16 v[200:203], v[44:47], a[248:251], v[200:203]
    ds_read_b128 v[40:43], v12 offset:32768
    v_mfma_f32_16x16x32_bf16 v[204:207], v[44:47], a[252:255], v[204:207]
    ds_read_b128 v[44:47], v12 offset:36864
    v_mfma_f32_16x16x32_bf16 v[176:179], v[48:51], v[224:227], v[176:179]
    buffer_store_dwordx4 v[148:151], v23, s[24:27], 0 offen sc1
    v_mfma_f32_16x16x32_bf16 v[180:183], v[48:51], v[228:231], v[180:183]
    v_mfma_f32_16x16x32_bf16 v[184:187], v[48:51], v[232:235], v[184:187]
    v_mfma_f32_16x16x32_bf16 v[188:191], v[48:51], v[236:239], v[188:191]
    ds_read_b128 v[48:51], v13 offset:32768
    v_cndmask_b32_dpp v158, v146, v147, vcc row_ror:8 row_mask:0xf bank_mask:0xf
    v_mfma_f32_16x16x32_bf16 v[192:195], v[52:55], v[224:227], v[192:195]
    v_cndmask_b32_dpp v159, v154, v155, vcc row_ror:8 row_mask:0xf bank_mask:0xf
    s_not_b64 vcc, vcc
    v_mfma_f32_16x16x32_bf16 v[196:199], v[52:55], v[228:231], v[196:199]
    v_cndmask_b32_dpp v156, v147, v146, vcc row_ror:8 row_mask:0xf bank_mask:0xf
    v_cndmask_b32_dpp v157, v155, v154, vcc row_ror:8 row_mask:0xf bank_mask:0xf
    v_mfma_f32_16x16x32_bf16 v[200:203], v[52:55], v[232:235], v[200:203]
    v_mfma_f32_16x16x32_bf16 v[204:207], v[52:55], v[236:239], v[204:207]
    ds_read_b128 v[52:55], v13 offset:36864
    s_waitcnt lgkmcnt(2)
    v_mfma_f32_16x16x32_bf16 v[176:179], v[56:59], v[240:243], v[176:179]
    v_mfma_f32_16x16x32_bf16 v[180:183], v[56:59], v[244:247], v[180:183]
    v_mfma_f32_16x16x32_bf16 v[184:187], v[56:59], v[248:251], v[184:187]
    v_mfma_f32_16x16x32_bf16 v[188:191], v[56:59], v[252:255], v[188:191]
    ds_read_b128 v[56:59], v12 offset:40960
    v_mfma_f32_16x16x32_bf16 v[192:195], v[60:63], v[240:243], v[192:195]
    v_mfma_f32_16x16x32_bf16 v[196:199], v[60:63], v[244:247], v[196:199]
    v_mfma_f32_16x16x32_bf16 v[200:203], v[60:63], v[248:251], v[200:203]
    v_mfma_f32_16x16x32_bf16 v[204:207], v[60:63], v[252:255], v[204:207]
    ds_read_b128 v[60:63], v12 offset:45056
    v_mfma_f32_16x16x32_bf16 v[80:83], v[40:43], a[0:3], 0
    v_mfma_f32_16x16x32_bf16 v[84:87], v[40:43], a[4:7], 0
    v_mfma_f32_16x16x32_bf16 v[88:91], v[40:43], a[8:11], 0
    v_mfma_f32_16x16x32_bf16 v[92:95], v[40:43], a[12:15], 0
    ds_read_b128 v[40:43], v13 offset:40960
    v_mfma_f32_16x16x32_bf16 v[96:99], v[44:47], a[0:3], 0
    buffer_store_dwordx4 v[156:159], v23, s[24:27], s73 offen sc1
    v_mfma_f32_16x16x32_bf16 v[100:103], v[44:47], a[4:7], 0
    v_mfma_f32_16x16x32_bf16 v[104:107], v[44:47], a[8:11], 0
    v_mfma_f32_16x16x32_bf16 v[108:111], v[44:47], a[12:15], 0
    ds_read_b128 v[44:47], v13 offset:45056
    v_cvt_pk_bf16_f32 v160, v160, v164
    v_cvt_pk_bf16_f32 v161, v161, v165
    v_cvt_pk_bf16_f32 v162, v162, v166
    v_cvt_pk_bf16_f32 v163, v163, v167
    s_waitcnt lgkmcnt(2)
    v_mfma_f32_16x16x32_bf16 v[80:83], v[48:51], a[16:19], v[80:83]
    v_cvt_pk_bf16_f32 v168, v168, v172
    v_cvt_pk_bf16_f32 v169, v169, v173
    v_mfma_f32_16x16x32_bf16 v[84:87], v[48:51], a[20:23], v[84:87]
    v_cvt_pk_bf16_f32 v170, v170, v174
    v_cvt_pk_bf16_f32 v171, v171, v175
    v_mfma_f32_16x16x32_bf16 v[88:91], v[48:51], a[24:27], v[88:91]
    v_cndmask_b32_dpp v164, v161, v160, vcc row_ror:8 row_mask:0xf bank_mask:0xf
    v_cndmask_b32_dpp v165, v169, v168, vcc row_ror:8 row_mask:0xf bank_mask:0xf
    v_mfma_f32_16x16x32_bf16 v[92:95], v[48:51], a[28:31], v[92:95]
    ds_read_b128 v[48:51], v12 offset:49152
    s_not_b64 vcc, vcc
    v_mfma_f32_16x16x32_bf16 v[96:99], v[52:55], a[16:19], v[96:99]
    v_cndmask_b32_dpp v166, v160, v161, vcc row_ror:8 row_mask:0xf bank_mask:0xf
    v_cndmask_b32_dpp v167, v168, v169, vcc row_ror:8 row_mask:0xf bank_mask:0xf
    v_mfma_f32_16x16x32_bf16 v[100:103], v[52:55], a[20:23], v[100:103]
    v_mfma_f32_16x16x32_bf16 v[104:107], v[52:55], a[24:27], v[104:107]
    v_mfma_f32_16x16x32_bf16 v[108:111], v[52:55], a[28:31], v[108:111]
    ds_read_b128 v[52:55], v12 offset:53248
    v_mfma_f32_16x16x32_bf16 v[80:83], v[56:59], a[32:35], v[80:83]
    v_mfma_f32_16x16x32_bf16 v[84:87], v[56:59], a[36:39], v[84:87]
    v_mfma_f32_16x16x32_bf16 v[88:91], v[56:59], a[40:43], v[88:91]
    v_mfma_f32_16x16x32_bf16 v[92:95], v[56:59], a[44:47], v[92:95]
    ds_read_b128 v[56:59], v13 offset:49152
    v_mfma_f32_16x16x32_bf16 v[96:99], v[60:63], a[32:35], v[96:99]
    v_mfma_f32_16x16x32_bf16 v[100:103], v[60:63], a[36:39], v[100:103]
    v_mfma_f32_16x16x32_bf16 v[104:107], v[60:63], a[40:43], v[104:107]
    v_mfma_f32_16x16x32_bf16 v[108:111], v[60:63], a[44:47], v[108:111]
    ds_read_b128 v[60:63], v13 offset:53248
    s_waitcnt lgkmcnt(2)
    v_mfma_f32_16x16x32_bf16 v[80:83], v[40:43], a[48:51], v[80:83]
    buffer_store_dwordx4 v[164:167], v23, s[24:27], s74 offen sc1
    v_mfma_f32_16x16x32_bf16 v[84:87], v[40:43], a[52:55], v[84:87]
    v_mfma_f32_16x16x32_bf16 v[88:91], v[40:43], a[56:59], v[88:91]
    v_mfma_f32_16x16x32_bf16 v[92:95], v[40:43], a[60:63], v[92:95]
    ds_read_b128 v[40:43], v12 offset:57344
    v_cndmask_b32_dpp v174, v162, v163, vcc row_ror:8 row_mask:0xf bank_mask:0xf
    v_mfma_f32_16x16x32_bf16 v[96:99], v[44:47], a[48:51], v[96:99]
    v_cndmask_b32_dpp v175, v170, v171, vcc row_ror:8 row_mask:0xf bank_mask:0xf
    s_not_b64 vcc, vcc
    v_mfma_f32_16x16x32_bf16 v[100:103], v[44:47], a[52:55], v[100:103]
    v_cndmask_b32_dpp v172, v163, v162, vcc row_ror:8 row_mask:0xf bank_mask:0xf
    v_cndmask_b32_dpp v173, v171, v170, vcc row_ror:8 row_mask:0xf bank_mask:0xf
    v_mfma_f32_16x16x32_bf16 v[104:107], v[44:47], a[56:59], v[104:107]
    v_mfma_f32_16x16x32_bf16 v[108:111], v[44:47], a[60:63], v[108:111]
    ds_read_b128 v[44:47], v12 offset:61440
    v_mfma_f32_16x16x32_bf16 v[80:83], v[48:51], a[64:67], v[80:83]
    v_mfma_f32_16x16x32_bf16 v[84:87], v[48:51], a[68:71], v[84:87]
    v_mfma_f32_16x16x32_bf16 v[88:91], v[48:51], a[72:75], v[88:91]
    v_mfma_f32_16x16x32_bf16 v[92:95], v[48:51], a[76:79], v[92:95]
    ds_read_b128 v[48:51], v13 offset:57344
    v_mfma_f32_16x16x32_bf16 v[96:99], v[52:55], a[64:67], v[96:99]
    v_mfma_f32_16x16x32_bf16 v[100:103], v[52:55], a[68:71], v[100:103]
    v_mfma_f32_16x16x32_bf16 v[104:107], v[52:55], a[72:75], v[104:107]
    v_mfma_f32_16x16x32_bf16 v[108:111], v[52:55], a[76:79], v[108:111]
    ds_read_b128 v[52:55], v13 offset:61440
    s_waitcnt lgkmcnt(2)
    v_mfma_f32_16x16x32_bf16 v[80:83], v[56:59], a[80:83], v[80:83]
    v_mfma_f32_16x16x32_bf16 v[84:87], v[56:59], a[84:87], v[84:87]
    v_mfma_f32_16x16x32_bf16 v[88:91], v[56:59], a[88:91], v[88:91]
    v_mfma_f32_16x16x32_bf16 v[92:95], v[56:59], a[92:95], v[92:95]
    ds_read_b128 v[56:59], v14 offset:0
    v_mfma_f32_16x16x32_bf16 v[96:99], v[60:63], a[80:83], v[96:99]
    buffer_store_dwordx4 v[172:175], v23, s[24:27], s75 offen sc1
    v_mfma_f32_16x16x32_bf16 v[100:103], v[60:63], a[84:87], v[100:103]
    v_mfma_f32_16x16x32_bf16 v[104:107], v[60:63], a[88:91], v[104:107]
    v_mfma_f32_16x16x32_bf16 v[108:111], v[60:63], a[92:95], v[108:111]
    ds_read_b128 v[60:63], v14 offset:4096
    v_lshl_add_u32 v23, s88, 3, v22
    v_cvt_pk_bf16_f32 v176, v176, v180
    v_cvt_pk_bf16_f32 v177, v177, v181
    v_cvt_pk_bf16_f32 v178, v178, v182
    v_cvt_pk_bf16_f32 v179, v179, v183
    v_mfma_f32_16x16x32_bf16 v[80:83], v[40:43], a[96:99], v[80:83]
    v_cvt_pk_bf16_f32 v184, v184, v188
    v_cvt_pk_bf16_f32 v185, v185, v189
    v_mfma_f32_16x16x32_bf16 v[84:87], v[40:43], a[100:103], v[84:87]
    v_cvt_pk_bf16_f32 v186, v186, v190
    v_cvt_pk_bf16_f32 v187, v187, v191
    v_mfma_f32_16x16x32_bf16 v[88:91], v[40:43], a[104:107], v[88:91]
    v_cndmask_b32_dpp v180, v177, v176, vcc row_ror:8 row_mask:0xf bank_mask:0xf
    v_cndmask_b32_dpp v181, v185, v184, vcc row_ror:8 row_mask:0xf bank_mask:0xf
    v_mfma_f32_16x16x32_bf16 v[92:95], v[40:43], a[108:111], v[92:95]
    ds_read_b128 v[40:43], v15 offset:0
    s_not_b64 vcc, vcc
    v_mfma_f32_16x16x32_bf16 v[96:99], v[44:47], a[96:99], v[96:99]
    v_cndmask_b32_dpp v182, v176, v177, vcc row_ror:8 row_mask:0xf bank_mask:0xf
    v_cndmask_b32_dpp v183, v184, v185, vcc row_ror:8 row_mask:0xf bank_mask:0xf
    v_mfma_f32_16x16x32_bf16 v[100:103], v[44:47], a[100:103], v[100:103]
    s_waitcnt vmcnt(4)
    s_barrier
    v_mfma_f32_16x16x32_bf16 v[104:107], v[44:47], a[104:107], v[104:107]
    v_mfma_f32_16x16x32_bf16 v[108:111], v[44:47], a[108:111], v[108:111]
    ds_read_b128 v[44:47], v15 offset:4096
    s_waitcnt lgkmcnt(2)
    v_mfma_f32_16x16x32_bf16 v[80:83], v[48:51], a[112:115], v[80:83]
    v_mfma_f32_16x16x32_bf16 v[84:87], v[48:51], a[116:119], v[84:87]
    v_mfma_f32_16x16x32_bf16 v[88:91], v[48:51], a[120:123], v[88:91]
    v_mfma_f32_16x16x32_bf16 v[92:95], v[48:51], a[124:127], v[92:95]
    ds_read_b128 v[48:51], v14 offset:8192
    v_mfma_f32_16x16x32_bf16 v[96:99], v[52:55], a[112:115], v[96:99]
    v_mfma_f32_16x16x32_bf16 v[100:103], v[52:55], a[116:119], v[100:103]
    v_mfma_f32_16x16x32_bf16 v[104:107], v[52:55], a[120:123], v[104:107]
    v_mfma_f32_16x16x32_bf16 v[108:111], v[52:55], a[124:127], v[108:111]
    ds_read_b128 v[52:55], v14 offset:12288
    v_mfma_f32_16x16x32_bf16 v[80:83], v[56:59], a[128:131], v[80:83]
    buffer_store_dwordx4 v[180:183], v23, s[24:27], 0 offen sc1
    v_mfma_f32_16x16x32_bf16 v[84:87], v[56:59], a[132:135], v[84:87]
    v_mfma_f32_16x16x32_bf16 v[88:91], v[56:59], a[136:139], v[88:91]
    v_mfma_f32_16x16x32_bf16 v[92:95], v[56:59], a[140:143], v[92:95]
    ds_read_b128 v[56:59], v15 offset:8192
    v_cndmask_b32_dpp v190, v178, v179, vcc row_ror:8 row_mask:0xf bank_mask:0xf
    v_mfma_f32_16x16x32_bf16 v[96:99], v[60:63], a[128:131], v[96:99]
    v_cndmask_b32_dpp v191, v186, v187, vcc row_ror:8 row_mask:0xf bank_mask:0xf
    s_not_b64 vcc, vcc
    v_mfma_f32_16x16x32_bf16 v[100:103], v[60:63], a[132:135], v[100:103]
    v_cndmask_b32_dpp v188, v179, v178, vcc row_ror:8 row_mask:0xf bank_mask:0xf
    v_cndmask_b32_dpp v189, v187, v186, vcc row_ror:8 row_mask:0xf bank_mask:0xf
    v_mfma_f32_16x16x32_bf16 v[104:107], v[60:63], a[136:139], v[104:107]
    v_mfma_f32_16x16x32_bf16 v[108:111], v[60:63], a[140:143], v[108:111]
    ds_read_b128 v[60:63], v15 offset:12288
    s_waitcnt lgkmcnt(2)
    v_mfma_f32_16x16x32_bf16 v[80:83], v[40:43], a[144:147], v[80:83]
    v_mfma_f32_16x16x32_bf16 v[84:87], v[40:43], a[148:151], v[84:87]
    v_mfma_f32_16x16x32_bf16 v[88:91], v[40:43], a[152:155], v[88:91]
    v_mfma_f32_16x16x32_bf16 v[92:95], v[40:43], a[156:159], v[92:95]
    ds_read_b128 v[40:43], v14 offset:16384
    v_mfma_f32_16x16x32_bf16 v[96:99], v[44:47], a[144:147], v[96:99]
    v_mfma_f32_16x16x32_bf16 v[100:103], v[44:47], a[148:151], v[100:103]
    v_mfma_f32_16x16x32_bf16 v[104:107], v[44:47], a[152:155], v[104:107]
    v_mfma_f32_16x16x32_bf16 v[108:111], v[44:47], a[156:159], v[108:111]
    ds_read_b128 v[44:47], v14 offset:20480
    v_mfma_f32_16x16x32_bf16 v[80:83], v[48:51], a[160:163], v[80:83]
    v_mfma_f32_16x16x32_bf16 v[84:87], v[48:51], a[164:167], v[84:87]
    v_mfma_f32_16x16x32_bf16 v[88:91], v[48:51], a[168:171], v[88:91]
    v_mfma_f32_16x16x32_bf16 v[92:95], v[48:51], a[172:175], v[92:95]
    ds_read_b128 v[48:51], v15 offset:16384
    v_mfma_f32_16x16x32_bf16 v[96:99], v[52:55], a[160:163], v[96:99]
    buffer_store_dwordx4 v[188:191], v23, s[24:27], s73 offen sc1
    v_mfma_f32_16x16x32_bf16 v[100:103], v[52:55], a[164:167], v[100:103]
    v_mfma_f32_16x16x32_bf16 v[104:107], v[52:55], a[168:171], v[104:107]
    v_mfma_f32_16x16x32_bf16 v[108:111], v[52:55], a[172:175], v[108:111]
    ds_read_b128 v[52:55], v15 offset:20480
    v_cvt_pk_bf16_f32 v192, v192, v196
    v_cvt_pk_bf16_f32 v193, v193, v197
    v_cvt_pk_bf16_f32 v194, v194, v198
    v_cvt_pk_bf16_f32 v195, v195, v199
    s_waitcnt lgkmcnt(2)
    v_mfma_f32_16x16x32_bf16 v[80:83], v[56:59], a[176:179], v[80:83]
L_tF3:
    s_cbranch_execz L_retF
    v_cvt_pk_bf16_f32 v200, v200, v204
    v_cvt_pk_bf16_f32 v201, v201, v205
    v_mfma_f32_16x16x32_bf16 v[84:87], v[56:59], a[180:183], v[84:87]
    v_cvt_pk_bf16_f32 v202, v202, v206
    v_cvt_pk_bf16_f32 v203, v203, v207
    v_mfma_f32_16x16x32_bf16 v[88:91], v[56:59], a[184:187], v[88:91]
    v_cndmask_b32_dpp v196, v193, v192, vcc row_ror:8 row_mask:0xf bank_mask:0xf
    v_cndmask_b32_dpp v197, v201, v200, vcc row_ror:8 row_mask:0xf bank_mask:0xf
    v_mfma_f32_16x16x32_bf16 v[92:95], v[56:59], a[188:191], v[92:95]
    ds_read_b128 v[56:59], v14 offset:24576
    s_not_b64 vcc, vcc
    v_mfma_f32_16x16x32_bf16 v[96:99], v[60:63], a[176:179], v[96:99]
    v_cndmask_b32_dpp v198, v192, v193, vcc row_ror:8 row_mask:0xf bank_mask:0xf
    v_cndmask_b32_dpp v199, v200, v201, vcc row_ror:8 row_mask:0xf bank_mask:0xf
    v_mfma_f32_16x16x32_bf16 v[100:103], v[60:63], a[180:183], v[100:103]
    v_mfma_f32_16x16x32_bf16 v[104:107], v[60:63], a[184:187], v[104:107]
    v_mfma_f32_16x16x32_bf16 v[108:111], v[60:63], a[188:191], v[108:111]
    ds_read_b128 v[60:63], v14 offset:28672
    v_mfma_f32_16x16x32_bf16 v[80:83], v[40:43], a[192:195], v[80:83]
    v_mfma_f32_16x16x32_bf16 v[84:87], v[40:43], a[196:199], v[84:87]
    v_mfma_f32_16x16x32_bf16 v[88:91], v[40:43], a[200:203], v[88:91]
    v_mfma_f32_16x16x32_bf16 v[92:95], v[40:43], a[204:207], v[92:95]
    ds_read_b128 v[40:43], v15 offset:24576
    v_mfma_f32_16x16x32_bf16 v[96:99], v[44:47], a[192:195], v[96:99]
    v_mfma_f32_16x16x32_bf16 v[100:103], v[44:47], a[196:199], v[100:103]
    v_mfma_f32_16x16x32_bf16 v[104:107], v[44:47], a[200:203], v[104:107]
    v_mfma_f32_16x16x32_bf16 v[108:111], v[44:47], a[204:207], v[108:111]
    ds_read_b128 v[44:47], v15 offset:28672
    s_waitcnt lgkmcnt(2)
    v_mfma_f32_16x16x32_bf16 v[80:83], v[48:51], a[208:211], v[80:83]
    buffer_store_dwordx4 v[196:199], v23, s[24:27], s74 offen sc1
    v_mfma_f32_16x16x32_bf16 v[84:87], v[48:51], a[212:215], v[84:87]
    v_mfma_f32_16x16x32_bf16 v[88:91], v[48:51], a[216:219], v[88:91]
    v_mfma_f32_16x16x32_bf16 v[92:95], v[48:51], a[220:223], v[92:95]
    ds_read_b128 v[48:51], v14 offset:32768
    v_cndmask_b32_dpp v206, v194, v195, vcc row_ror:8 row_mask:0xf bank_mask:0xf
    v_mfma_f32_16x16x32_bf16 v[96:99], v[52:55], a[208:211], v[96:99]
    v_cndmask_b32_dpp v207, v202, v203, vcc row_ror:8 row_mask:0xf bank_mask:0xf
    s_not_b64 vcc, vcc
    v_mfma_f32_16x16x32_bf16 v[100:103], v[52:55], a[212:215], v[100:103]
    v_cndmask_b32_dpp v204, v195, v194, vcc row_ror:8 row_mask:0xf bank_mask:0xf
    v_cndmask_b32_dpp v205, v203, v202, vcc row_ror:8 row_mask:0xf bank_mask:0xf
    v_mfma_f32_16x16x32_bf16 v[104:107], v[52:55], a[216:219], v[104:107]
    v_mfma_f32_16x16x32_bf16 v[108:111], v[52:55], a[220:223], v[108:111]
    ds_read_b128 v[52:55], v15 offset:32768
    v_mfma_f32_16x16x32_bf16 v[80:83], v[56:59], a[224:227], v[80:83]
    v_mfma_f32_16x16x32_bf16 v[84:87], v[56:59], a[228:231], v[84:87]
    v_mfma_f32_16x16x32_bf16 v[88:91], v[56:59], a[232:235], v[88:91]
    v_mfma_f32_16x16x32_bf16 v[92:95], v[56:59], a[236:239], v[92:95]
    ds_read_b128 v[56:59], v14 offset:36864
    v_mfma_f32_16x16x32_bf16 v[96:99], v[60:63], a[224:227], v[96:99]
    v_mfma_f32_16x16x32_bf16 v[100:103], v[60:63], a[228:231], v[100:103]
    v_mfma_f32_16x16x32_bf16 v[104:107], v[60:63], a[232:235], v[104:107]
    v_mfma_f32_16x16x32_bf16 v[108:111], v[60:63], a[236:239], v[108:111]
    ds_read_b128 v[60:63], v15 offset:36864
    s_waitcnt lgkmcnt(2)
    v_mfma_f32_16x16x32_bf16 v[80:83], v[40:43], a[240:243], v[80:83]
    v_mfma_f32_16x16x32_bf16 v[84:87], v[40:43], a[244:247], v[84:87]
    v_mfma_f32_16x16x32_bf16 v[88:91], v[40:43], a[248:251], v[88:91]
    v_mfma_f32_16x16x32_bf16 v[92:95], v[40:43], a[252:255], v[92:95]
    v_mfma_f32_16x16x32_bf16 v[96:99], v[44:47], a[240:243], v[96:99]
    buffer_store_dwordx4 v[204:207], v23, s[24:27], s75 offen sc1
    v_mfma_f32_16x16x32_bf16 v[100:103], v[44:47], a[244:247], v[100:103]
    v_mfma_f32_16x16x32_bf16 v[104:107], v[44:47], a[248:251], v[104:107]
    v_mfma_f32_16x16x32_bf16 v[108:111], v[44:47], a[252:255], v[108:111]
    v_mfma_f32_16x16x32_bf16 v[80:83], v[48:51], v[224:227], v[80:83]
    v_mfma_f32_16x16x32_bf16 v[84:87], v[48:51], v[228:231], v[84:87]
    v_mfma_f32_16x16x32_bf16 v[88:91], v[48:51], v[232:235], v[88:91]
    v_mfma_f32_16x16x32_bf16 v[92:95], v[48:51], v[236:239], v[92:95]
    v_mfma_f32_16x16x32_bf16 v[80:83], v[52:55], v[240:243], v[80:83]
    v_mfma_f32_16x16x32_bf16 v[84:87], v[52:55], v[244:247], v[84:87]
    v_mfma_f32_16x16x32_bf16 v[88:91], v[52:55], v[248:251], v[88:91]
    v_mfma_f32_16x16x32_bf16 v[92:95], v[52:55], v[252:255], v[92:95]
    s_waitcnt lgkmcnt(0)
    v_mfma_f32_16x16x32_bf16 v[96:99], v[56:59], v[224:227], v[96:99]
    v_mfma_f32_16x16x32_bf16 v[100:103], v[56:59], v[228:231], v[100:103]
    v_mfma_f32_16x16x32_bf16 v[104:107], v[56:59], v[232:235], v[104:107]
    v_lshl_add_u32 v23, s89, 3, v22
    v_mfma_f32_16x16x32_bf16 v[108:111], v[56:59], v[236:239], v[108:111]
    s_nop 0
    v_cvt_pk_bf16_f32 v80, v80, v84
    v_cvt_pk_bf16_f32 v81, v81, v85
    v_cvt_pk_bf16_f32 v82, v82, v86
    v_cvt_pk_bf16_f32 v83, v83, v87
    v_mfma_f32_16x16x32_bf16 v[96:99], v[60:63], v[240:243], v[96:99]
    v_cvt_pk_bf16_f32 v88, v88, v92
    v_cvt_pk_bf16_f32 v89, v89, v93
    v_mfma_f32_16x16x32_bf16 v[100:103], v[60:63], v[244:247], v[100:103]
    v_cvt_pk_bf16_f32 v90, v90, v94
    v_cvt_pk_bf16_f32 v91, v91, v95
    v_mfma_f32_16x16x32_bf16 v[104:107], v[60:63], v[248:251], v[104:107]
    v_cndmask_b32_dpp v84, v81, v80, vcc row_ror:8 row_mask:0xf bank_mask:0xf
    v_cndmask_b32_dpp v85, v89, v88, vcc row_ror:8 row_mask:0xf bank_mask:0xf
    v_mfma_f32_16x16x32_bf16 v[108:111], v[60:63], v[252:255], v[108:111]
    s_not_b64 vcc, vcc
    v_cndmask_b32_dpp v86, v80, v81, vcc row_ror:8 row_mask:0xf bank_mask:0xf
    v_cndmask_b32_dpp v87, v88, v89, vcc row_ror:8 row_mask:0xf bank_mask:0xf
    buffer_store_dwordx4 v[84:87], v23, s[24:27], 0 offen sc1
    v_cndmask_b32_dpp v94, v82, v83, vcc row_ror:8 row_mask:0xf bank_mask:0xf
    v_cndmask_b32_dpp v95, v90, v91, vcc row_ror:8 row_mask:0xf bank_mask:0xf
    s_not_b64 vcc, vcc
    v_cndmask_b32_dpp v92, v83, v82, vcc row_ror:8 row_mask:0xf bank_mask:0xf
    v_cndmask_b32_dpp v93, v91, v90, vcc row_ror:8 row_mask:0xf bank_mask:0xf
    buffer_store_dwordx4 v[92:95], v23, s[24:27], s73 offen sc1
    v_cvt_pk_bf16_f32 v96, v96, v100
    v_cvt_pk_bf16_f32 v97, v97, v101
    v_cvt_pk_bf16_f32 v98, v98, v102
    v_cvt_pk_bf16_f32 v99, v99, v103
    v_cvt_pk_bf16_f32 v104, v104, v108
    v_cvt_pk_bf16_f32 v105, v105, v109
    v_cvt_pk_bf16_f32 v106, v106, v110
    v_cvt_pk_bf16_f32 v107, v107, v111
    v_cndmask_b32_dpp v100, v97, v96, vcc row_ror:8 row_mask:0xf bank_mask:0xf
    v_cndmask_b32_dpp v101, v105, v104, vcc row_ror:8 row_mask:0xf bank_mask:0xf
    s_not_b64 vcc, vcc
    v_cndmask_b32_dpp v102, v96, v97, vcc row_ror:8 row_mask:0xf bank_mask:0xf
    v_cndmask_b32_dpp v103, v104, v105, vcc row_ror:8 row_mask:0xf bank_mask:0xf
    buffer_store_dwordx4 v[100:103], v23, s[24:27], s74 offen sc1
    v_cndmask_b32_dpp v110, v98, v99, vcc row_ror:8 row_mask:0xf bank_mask:0xf
    v_cndmask_b32_dpp v111, v106, v107, vcc row_ror:8 row_mask:0xf bank_mask:0xf
    s_not_b64 vcc, vcc
    v_cndmask_b32_dpp v108, v99, v98, vcc row_ror:8 row_mask:0xf bank_mask:0xf
    v_cndmask_b32_dpp v109, v107, v106, vcc row_ror:8 row_mask:0xf bank_mask:0xf
    buffer_store_dwordx4 v[108:111], v23, s[24:27], s75 offen sc1
.if (.-L_pathF) != 17344
.error "size model mismatch"
.endif
L_fin:
L_fastend:
    s_endpgm
L_slow:
    s_waitcnt vmcnt(0) lgkmcnt(0)
    s_setreg_imm32_b32 hwreg(HW_REG_MODE, 4, 2), 3
    v_and_b32 v3, 31, v2
    v_lshrrev_b32 v4, 5, v2
    v_mul_u32_u24 v5, 147456, v4
    v_lshl_add_u32 v5, v3, 2, v5
    v_lshlrev_b32 v6, 1, v3
    v_mul_u32_u24 v10, 1152, v3
    v_lshl_add_u32 v10, v4, 4, v10
    v_mul_u32_u24 v7, 36864, v4
    v_add_u32 v7, v7, v6
    s_mov_b32 s38, 0xffff0000
    s_mov_b32 s60, 0
    s_mov_b32 s61, 9216
    s_mov_b32 s62, 18432
    s_mov_b32 s63, 27648
    s_mov_b32 s64, 73728
    s_mov_b32 s65, 82944
    s_mov_b32 s66, 92160
    s_mov_b32 s67, 101376
    s_mov_b32 s68, 147456
    s_mov_b32 s69, 156672
    s_mov_b32 s70, 165888
    s_mov_b32 s71, 175104
    s_mov_b32 s72, 221184
    s_mov_b32 s73, 230400
    s_mov_b32 s74, 239616
    s_mov_b32 s75, 248832
L_s0:
    s_mov_b32 s44, 0
L_s1:
    s_lshl_b32 s45, s44, 6
    s_add_u32 s45, s45, s34
    buffer_load_ushort v8, v6, s[16:19], s45 offen
    buffer_load_ushort v9, v6, s[20:23], s45 offen
    s_lshl_b32 s46, s45, 1
    s_mov_b32 s47, s85
    v_mov_b32 v32, 0
    v_mov_b32 v33, 0
    v_mov_b32 v34, 0
    v_mov_b32 v35, 0
    v_mov_b32 v36, 0
    v_mov_b32 v37, 0
    v_mov_b32 v38, 0
    v_mov_b32 v39, 0
    v_mov_b32 v40, 0
    v_mov_b32 v41, 0
    v_mov_b32 v42, 0
    v_mov_b32 v43, 0
    v_mov_b32 v44, 0
    v_mov_b32 v45, 0
    v_mov_b32 v46, 0
    v_mov_b32 v47, 0
    s_mov_b32 s48, 0
    s_waitcnt vmcnt(0)
    v_lshlrev_b32 v8, 16, v8
    v_lshlrev_b32 v9, 16, v9
L_s3:
    s_add_u32 s49, s46, 0
    buffer_load_dword v16, v5, s[12:15], s49 offen
    s_add_u32 s49, s46, 18432
    buffer_load_dword v17, v5, s[12:15], s49 offen
    s_add_u32 s49, s46, 36864
    buffer_load_dword v18, v5, s[12:15], s49 offen
    s_add_u32 s49, s46, 55296
    buffer_load_dword v19, v5, s[12:15], s49 offen
    s_add_u32 s49, s46, 73728
    buffer_load_dword v20, v5, s[12:15], s49 offen
    s_add_u32 s49, s46, 92160
    buffer_load_dword v21, v5, s[12:15], s49 offen
    s_add_u32 s49, s46, 110592
    buffer_load_dword v22, v5, s[12:15], s49 offen
    s_add_u32 s49, s46, 129024
    buffer_load_dword v23, v5, s[12:15], s49 offen
    buffer_load_dwordx4 v[28:31], v10, s[8:11], s47 offen
    s_add_u32 s46, s46, 294912
    s_add_u32 s47, s47, 32
    s_waitcnt vmcnt(0)
    v_cvt_f32_i32 v16, v16
    v_cvt_f32_i32 v17, v17
    v_cvt_pk_bf16_f32 v17, v16, v17
    v_lshlrev_b32 v16, 16, v17
    v_and_b32 v17, s38, v17
    v_sub_f32 v16, v16, v9
    v_sub_f32 v17, v17, v9
    v_cvt_pk_bf16_f32 v17, v16, v17
    v_lshlrev_b32 v16, 16, v17
    v_and_b32 v17, s38, v17
    v_mul_f32 v16, v16, v8
    v_mul_f32 v17, v17, v8
    v_cvt_pk_bf16_f32 v24, v16, v17
    v_cvt_f32_i32 v18, v18
    v_cvt_f32_i32 v19, v19
    v_cvt_pk_bf16_f32 v19, v18, v19
    v_lshlrev_b32 v18, 16, v19
    v_and_b32 v19, s38, v19
    v_sub_f32 v18, v18, v9
    v_sub_f32 v19, v19, v9
    v_cvt_pk_bf16_f32 v19, v18, v19
    v_lshlrev_b32 v18, 16, v19
    v_and_b32 v19, s38, v19
    v_mul_f32 v18, v18, v8
    v_mul_f32 v19, v19, v8
    v_cvt_pk_bf16_f32 v25, v18, v19
    v_cvt_f32_i32 v20, v20
    v_cvt_f32_i32 v21, v21
    v_cvt_pk_bf16_f32 v21, v20, v21
    v_lshlrev_b32 v20, 16, v21
    v_and_b32 v21, s38, v21
    v_sub_f32 v20, v20, v9
    v_sub_f32 v21, v21, v9
    v_cvt_pk_bf16_f32 v21, v20, v21
    v_lshlrev_b32 v20, 16, v21
    v_and_b32 v21, s38, v21
    v_mul_f32 v20, v20, v8
    v_mul_f32 v21, v21, v8
    v_cvt_pk_bf16_f32 v26, v20, v21
    v_cvt_f32_i32 v22, v22
    v_cvt_f32_i32 v23, v23
    v_cvt_pk_bf16_f32 v23, v22, v23
    v_lshlrev_b32 v22, 16, v23
    v_and_b32 v23, s38, v23
    v_sub_f32 v22, v22, v9
    v_sub_f32 v23, v23, v9
    v_cvt_pk_bf16_f32 v23, v22, v23
    v_lshlrev_b32 v22, 16, v23
    v_and_b32 v23, s38, v23
    v_mul_f32 v22, v22, v8
    v_mul_f32 v23, v23, v8
    v_cvt_pk_bf16_f32 v27, v22, v23
    s_add_u32 s48, s48, 1
    s_cmp_lg_u32 s48, 36
    v_mfma_f32_32x32x16_bf16 v[32:47], v[28:31], v[24:27], v[32:47]
    s_cbranch_scc1 L_s3
    s_lshl_b32 s47, s85, 3
    s_add_u32 s47, s47, s45
    s_nop 7
    s_nop 7
    v_cvt_pk_bf16_f32 v32, v32, v32
    s_add_u32 s49, s47, s60
    buffer_store_short v32, v7, s[24:27], s49 offen
    v_cvt_pk_bf16_f32 v33, v33, v33
    s_add_u32 s49, s47, s61
    buffer_store_short v33, v7, s[24:27], s49 offen
    v_cvt_pk_bf16_f32 v34, v34, v34
    s_add_u32 s49, s47, s62
    buffer_store_short v34, v7, s[24:27], s49 offen
    v_cvt_pk_bf16_f32 v35, v35, v35
    s_add_u32 s49, s47, s63
    buffer_store_short v35, v7, s[24:27], s49 offen
    v_cvt_pk_bf16_f32 v36, v36, v36
    s_add_u32 s49, s47, s64
    buffer_store_short v36, v7, s[24:27], s49 offen
    v_cvt_pk_bf16_f32 v37, v37, v37
    s_add_u32 s49, s47, s65
    buffer_store_short v37, v7, s[24:27], s49 offen
    v_cvt_pk_bf16_f32 v38, v38, v38
    s_add_u32 s49, s47, s66
    buffer_store_short v38, v7, s[24:27], s49 offen
    v_cvt_pk_bf16_f32 v39, v39, v39
    s_add_u32 s49, s47, s67
    buffer_store_short v39, v7, s[24:27], s49 offen
    v_cvt_pk_bf16_f32 v40, v40, v40
    s_add_u32 s49, s47, s68
    buffer_store_short v40, v7, s[24:27], s49 offen
    v_cvt_pk_bf16_f32 v41, v41, v41
    s_add_u32 s49, s47, s69
    buffer_store_short v41, v7, s[24:27], s49 offen
    v_cvt_pk_bf16_f32 v42, v42, v42
    s_add_u32 s49, s47, s70
    buffer_store_short v42, v7, s[24:27], s49 offen
    v_cvt_pk_bf16_f32 v43, v43, v43
    s_add_u32 s49, s47, s71
    buffer_store_short v43, v7, s[24:27], s49 offen
    v_cvt_pk_bf16_f32 v44, v44, v44
    s_add_u32 s49, s47, s72
    buffer_store_short v44, v7, s[24:27], s49 offen
    v_cvt_pk_bf16_f32 v45, v45, v45
    s_add_u32 s49, s47, s73
    buffer_store_short v45, v7, s[24:27], s49 offen
    v_cvt_pk_bf16_f32 v46, v46, v46
    s_add_u32 s49, s47, s74
    buffer_store_short v46, v7, s[24:27], s49 offen
    v_cvt_pk_bf16_f32 v47, v47, v47
    s_add_u32 s49, s47, s75
    buffer_store_short v47, v7, s[24:27], s49 offen
    s_add_u32 s44, s44, 1
    s_cmp_lg_u32 s44, 2
    s_cbranch_scc1 L_s1
    s_mov_b32 s85, s86
    s_mov_b32 s86, s87
    s_mov_b32 s87, s88
    s_mov_b32 s88, s89
    s_sub_u32 s7, s7, 1
    s_cmp_lg_u32 s7, 0
    s_cbranch_scc1 L_s0
    s_branch L_fin
L_done:
    s_endpgm
.section .rodata,"a"
.p2align 6
.amdhsa_kernel standalone__w4a16_gemm_dequant__prompt_kernel
  .amdhsa_next_free_vgpr 512
  .amdhsa_next_free_sgpr 102
  .amdhsa_accum_offset 256
  .amdhsa_group_segment_fixed_size 0
  .amdhsa_kernarg_size 56
  .amdhsa_user_sgpr_count 2
  .amdhsa_user_sgpr_kernarg_segment_ptr 1
  .amdhsa_system_sgpr_workgroup_id_x 1
.end_amdhsa_kernel
```
